```python
import torch

def _softmax(x, axis=-1):
    return torch.softmax(x, dim=axis)

def _gelu(x):
    return torch.nn.functional.gelu(x, approximate='tanh')

def _silu(x):
    return torch.nn.functional.silu(x)

def _sigmoid(x):
    return torch.sigmoid(x)

def _layernorm(x, axis=-1, eps=1e-05):
    m = x.mean(dim=axis, keepdim=True)
    v = x.var(dim=axis, keepdim=True, unbiased=False)
    return (x - m) / torch.sqrt(v + eps)

def _scatter_add(tgt, idx, src, axis=0):
    return tgt.clone().index_add_(axis, idx, src)

def _segment_sum(src, seg, n):
    out = torch.zeros((n,) + src.shape[1:], dtype=src.dtype)
    return out.index_add_(0, seg, src)

def _pad(x, pw):
    flat = tuple((v for pair in reversed(pw) for v in pair))
    return torch.nn.functional.pad(x, flat)
kernel_name = 'standalone__autoregressive_conv_wavernn__speech'

def setup_inputs():

    _w = lambda a: (lambda t: t.to(torch.bfloat16) if t.is_floating_point() else t)(torch.as_tensor(a))
    B, T, D, K = (2, 1000, 512, 15)
    return {'x': _w((lambda *s: torch.randn(*s, dtype=torch.bfloat16) * 0.05)(B, T, D)), 'w': _w((lambda *s: torch.randn(*s, dtype=torch.bfloat16) * 0.05)(K, D, 2 * D))}

def reference(x, w):
    B, T, D = x.shape
    K = w.shape[0]
    dil = 2
    pad = (K - 1) * dil
    xp = _pad(x, ((0, 0), (pad, 0), (0, 0)))
    h = torch.einsum('btd,de->bte', xp[:, 0:T, :], w[0])
    for i in range(1, K):
        h = h + torch.einsum('btd,de->bte', xp[:, i * dil:i * dil + T, :], w[i])
    f, g = (h[..., :D].clone(), h[..., D:].clone())
    return torch.tanh(f) * _sigmoid(g)
```

```asm
; @launch grid=(256,1,1) block=(320,1,1) lds=163840
.amdgcn_target "amdgcn-amd-amdhsa--gfx950"
.text
.globl standalone__autoregressive_conv_wavernn__speech_kernel
.p2align 8
.type standalone__autoregressive_conv_wavernn__speech_kernel,@function
standalone__autoregressive_conv_wavernn__speech_kernel:

    s_cmp_ge_u32 s2, 256
    s_cbranch_scc1 L_done

    s_load_dwordx4 s[4:7], s[0:1], 0
    s_load_dwordx4 s[64:67], s[0:1], 16
    s_load_dwordx2 s[68:69], s[0:1], 32
    v_lshrrev_b32 v1, 6, v0
    v_and_b32 v2, 63, v0
    s_add_u32 s39, s2, 3
    s_and_b32 s39, s39, 7
    v_readfirstlane_b32 s28, v1
    s_lshr_b32 s32, s2, 3
    s_lshr_b32 s38, s32, 4
    s_and_b32 s37, s32, 15
    s_mul_i32 s33, s38, 7
    s_add_u32 s39, s39, s33
    s_and_b32 s39, s39, 7
    s_and_b32 s35, s37, 3
    s_mul_i32 s41, s35, 125
    s_lshr_b32 s32, s37, 3
    s_mul_i32 s40, s32, 1000
    s_lshr_b32 s32, s37, 2
    s_and_b32 s32, s32, 1
    s_add_u32 s40, s40, s32
    s_lshl_b32 s32, s41, 1
    s_add_u32 s40, s40, s32
    s_mul_i32 s29, s28, 20480
    s_add_u32 s29, s29, 73728
    s_mul_i32 s36, s28, 9216
    s_mov_b32 s44, 0
    s_mov_b32 s48, 0
    s_mov_b32 s45, 262144
    s_mov_b32 s49, 256
    s_mov_b32 s46, 524288
    s_mov_b32 s50, 512
    s_mov_b32 s47, 786432
    s_mov_b32 s51, 768
    s_cmp_eq_u32 s28, 4
    s_cbranch_scc1 L_helper

    v_lshrrev_b32 v3, 4, v2
    v_and_b32 v4, 15, v2
    s_lshl_b32 s33, s28, 1
    s_sub_u32 s32, s40, 28
    v_mov_b32 v1, 0x40000000

    v_add_u32 v5, 0, v3
    v_and_b32 v6, 7, v5
    v_lshlrev_b32 v6, 1, v6
    v_xor_b32 v6, v6, v4
    v_lshlrev_b32 v6, 4, v6
    v_lshl_add_u32 v5, v5, 3, s33
    v_add_u32 v7, s41, v5
    v_cmp_gt_u32 vcc, 14, v7
    v_lshl_add_u32 v5, v5, 1, s32
    v_lshl_add_u32 v5, v5, 10, v6
    v_cndmask_b32 v19, v5, v1, vcc

    v_add_u32 v5, 4, v3
    v_and_b32 v6, 7, v5
    v_lshlrev_b32 v6, 1, v6
    v_xor_b32 v6, v6, v4
    v_lshlrev_b32 v6, 4, v6
    v_lshl_add_u32 v5, v5, 3, s33
    v_add_u32 v7, s41, v5
    v_cmp_gt_u32 vcc, 14, v7
    v_lshl_add_u32 v5, v5, 1, s32
    v_lshl_add_u32 v5, v5, 10, v6
    v_cndmask_b32 v20, v5, v1, vcc

    v_add_u32 v5, 8, v3
    v_and_b32 v6, 7, v5
    v_lshlrev_b32 v6, 1, v6
    v_xor_b32 v6, v6, v4
    v_lshlrev_b32 v6, 4, v6
    v_lshl_add_u32 v5, v5, 3, s33
    v_add_u32 v7, s41, v5
    v_cmp_gt_u32 vcc, 14, v7
    v_lshl_add_u32 v5, v5, 1, s32
    v_lshl_add_u32 v5, v5, 10, v6
    v_cndmask_b32 v21, v5, v1, vcc

    v_add_u32 v5, 12, v3
    v_and_b32 v6, 7, v5
    v_lshlrev_b32 v6, 1, v6
    v_xor_b32 v6, v6, v4
    v_lshlrev_b32 v6, 4, v6
    v_lshl_add_u32 v5, v5, 3, s33
    v_add_u32 v7, s41, v5
    v_cmp_gt_u32 vcc, 14, v7
    v_lshl_add_u32 v5, v5, 1, s32
    v_lshl_add_u32 v5, v5, 10, v6
    v_cndmask_b32 v22, v5, v1, vcc

    v_add_u32 v5, 16, v3
    v_cmp_le_u32 vcc, 18, v5
    v_subrev_u32 v6, 18, v5
    v_mov_b32 v7, 0
    v_cndmask_b32 v5, v5, v6, vcc
    v_cndmask_b32 v7, v7, 1, vcc
    v_and_b32 v6, 7, v5
    v_lshlrev_b32 v6, 1, v6
    v_xor_b32 v6, v6, v4
    v_lshlrev_b32 v6, 4, v6
    v_lshl_add_u32 v5, v5, 3, v7
    v_add_u32 v5, s33, v5
    v_add_u32 v7, s41, v5
    v_cmp_gt_u32 vcc, 14, v7
    v_lshl_add_u32 v5, v5, 1, s32
    v_lshl_add_u32 v5, v5, 10, v6
    v_cndmask_b32 v23, v5, v1, vcc

    v_add_u32 v5, 2, v3
    v_and_b32 v6, 7, v5
    v_lshlrev_b32 v6, 1, v6
    v_xor_b32 v6, v6, v4
    v_lshlrev_b32 v6, 4, v6
    v_lshl_add_u32 v5, v5, 3, s33
    v_add_u32 v5, 1, v5
    v_add_u32 v7, s41, v5
    v_cmp_gt_u32 vcc, 14, v7
    v_lshl_add_u32 v5, v5, 1, s32
    v_lshl_add_u32 v5, v5, 10, v6
    v_cndmask_b32 v24, v5, v1, vcc

    v_add_u32 v5, 6, v3
    v_and_b32 v6, 7, v5
    v_lshlrev_b32 v6, 1, v6
    v_xor_b32 v6, v6, v4
    v_lshlrev_b32 v6, 4, v6
    v_lshl_add_u32 v5, v5, 3, s33
    v_add_u32 v5, 1, v5
    v_add_u32 v7, s41, v5
    v_cmp_gt_u32 vcc, 14, v7
    v_lshl_add_u32 v5, v5, 1, s32
    v_lshl_add_u32 v5, v5, 10, v6
    v_cndmask_b32 v25, v5, v1, vcc

    v_add_u32 v5, 10, v3
    v_and_b32 v6, 7, v5
    v_lshlrev_b32 v6, 1, v6
    v_xor_b32 v6, v6, v4
    v_lshlrev_b32 v6, 4, v6
    v_lshl_add_u32 v5, v5, 3, s33
    v_add_u32 v5, 1, v5
    v_add_u32 v7, s41, v5
    v_cmp_gt_u32 vcc, 14, v7
    v_lshl_add_u32 v5, v5, 1, s32
    v_lshl_add_u32 v5, v5, 10, v6
    v_cndmask_b32 v26, v5, v1, vcc

    v_add_u32 v5, 14, v3
    v_and_b32 v6, 7, v5
    v_lshlrev_b32 v6, 1, v6
    v_xor_b32 v6, v6, v4
    v_lshlrev_b32 v6, 4, v6
    v_lshl_add_u32 v5, v5, 3, s33
    v_add_u32 v5, 1, v5
    v_add_u32 v7, s41, v5
    v_cmp_gt_u32 vcc, 14, v7
    v_lshl_add_u32 v5, v5, 1, s32
    v_lshl_add_u32 v5, v5, 10, v6
    v_cndmask_b32 v27, v5, v1, vcc

    v_lshrrev_b32 v3, 3, v2
    v_and_b32 v4, 7, v2
    v_lshrrev_b32 v5, 4, v2
    v_and_b32 v5, 1, v5
    v_lshlrev_b32 v5, 1, v5
    v_xor_b32 v4, v4, v5
    s_lshl_b32 s32, s28, 5
    v_add_u32 v3, s32, v3
    v_lshlrev_b32 v3, 11, v3
    s_lshl_b32 s32, s39, 7
    s_lshl_b32 s33, s38, 10
    s_xor_b32 s33, s33, 1024
    s_add_u32 s32, s32, s33
    v_add_u32 v3, s32, v3
    v_xor_b32 v5, 4, v4
    v_lshl_add_u32 v15, v4, 4, v3
    v_lshl_add_u32 v16, v5, 4, v3
    v_add_u32 v17, 30720, v15
    v_add_u32 v18, 46080, v16
    v_add_u32 v16, 15360, v16
    s_waitcnt lgkmcnt(0)

    s_mov_b32 s8, s4
    s_and_b32 s9, s5, 0xffff
    s_mov_b32 s10, 2048000
    s_mov_b32 s11, 0x00020000
    s_mov_b32 s12, s6
    s_and_b32 s13, s7, 0xffff
    s_mov_b32 s14, 15728640
    s_mov_b32 s15, 0x00020000
    s_add_u32 m0, s36, 0
    s_nop 0
    buffer_load_dwordx4 v19, s[8:11], s48 offen lds
    s_add_u32 m0, s36, 1024
    s_nop 0
    buffer_load_dwordx4 v20, s[8:11], s48 offen lds
    s_add_u32 m0, s36, 2048
    s_nop 0
    buffer_load_dwordx4 v21, s[8:11], s48 offen lds
    s_add_u32 m0, s36, 3072
    s_nop 0
    buffer_load_dwordx4 v22, s[8:11], s48 offen lds
    s_add_u32 m0, s36, 4096
    s_nop 0
    buffer_load_dwordx4 v23, s[8:11], s48 offen lds
    s_add_u32 m0, s36, 5120
    s_nop 0
    buffer_load_dwordx4 v24, s[8:11], s48 offen lds
    s_add_u32 m0, s36, 6144
    s_nop 0
    buffer_load_dwordx4 v25, s[8:11], s48 offen lds
    s_add_u32 m0, s36, 7168
    s_nop 0
    buffer_load_dwordx4 v26, s[8:11], s48 offen lds
    s_add_u32 m0, s36, 8192
    s_nop 0
    buffer_load_dwordx4 v27, s[8:11], s48 offen lds
    s_add_u32 m0, s29, 0
    s_add_u32 s32, s44, 0
    buffer_load_dwordx4 v15, s[12:15], s32 offen  lds
    buffer_load_dwordx4 v16, s[12:15], s32 offen offset:1024  lds
    buffer_load_dwordx4 v17, s[12:15], s32 offen offset:2048  lds
    buffer_load_dwordx4 v18, s[12:15], s32 offen offset:3072  lds

    s_mov_b32 s16, s64
    s_and_b32 s17, s65, 0xffff
    s_mov_b32 s18, 2048000
    s_mov_b32 s19, 0x00020000
    s_mov_b32 s24, s66
    s_and_b32 s25, s67, 0xffff
    s_mov_b32 s26, 256
    s_mov_b32 s27, 0x00020000
    s_mov_b32 s20, s68
    s_and_b32 s21, s69, 0xffff
    s_mov_b32 s22, 0x10000000
    s_mov_b32 s23, 0x00020000
    v_and_b32 v3, 15, v2
    v_lshrrev_b32 v4, 4, v2
    s_lshl_b32 s32, s28, 2
    v_add_u32 v4, s32, v4

    v_add_u32 v5, 0, v3
    v_and_b32 v6, 7, v5
    v_lshlrev_b32 v6, 1, v6
    v_xor_b32 v6, v6, v4
    v_lshlrev_b32 v6, 4, v6
    v_lshl_add_u32 v8, v5, 8, v6
    v_add_u32 v28, 36864, v8

    v_add_u32 v5, 1, v3
    v_and_b32 v6, 7, v5
    v_lshlrev_b32 v6, 1, v6
    v_xor_b32 v6, v6, v4
    v_lshlrev_b32 v6, 4, v6
    v_lshl_add_u32 v9, v5, 8, v6
    v_add_u32 v29, 36864, v9

    v_add_u32 v5, 2, v3
    v_and_b32 v6, 7, v5
    v_lshlrev_b32 v6, 1, v6
    v_xor_b32 v6, v6, v4
    v_lshlrev_b32 v6, 4, v6
    v_lshl_add_u32 v10, v5, 8, v6
    v_add_u32 v30, 36864, v10

    v_lshrrev_b32 v3, 4, v2
    v_lshrrev_b32 v4, 2, v2
    v_and_b32 v4, 3, v4
    v_lshl_add_u32 v5, v3, 3, v4
    v_lshrrev_b32 v6, 1, v4
    v_and_b32 v7, 1, v3
    v_lshl_add_u32 v6, v7, 1, v6
    v_lshlrev_b32 v6, 1, v6
    v_lshrrev_b32 v7, 1, v2
    v_and_b32 v7, 1, v7
    v_xor_b32 v6, v6, v7
    v_lshlrev_b32 v6, 4, v6
    v_lshl_add_u32 v5, v5, 7, v6
    v_and_b32 v6, 1, v2
    v_lshl_add_u32 v5, v6, 3, v5
    v_add_u32 v11, s29, v5
    v_xor_b32 v12, 32, v11
    v_xor_b32 v13, 64, v11
    v_xor_b32 v14, 0x60, v11
    s_lshl_b32 s32, s39, 4
    s_add_u32 s32, s32, s37
    s_lshr_b32 s33, s32, 3
    s_lshl_b32 s33, s33, 2
    s_add_u32 s33, s33, 64
    v_mov_b32 v31, s33
    s_and_b32 s56, s32, 7
    s_lshl_b32 s56, s56, 2
    s_xor_b32 s33, s38, 1
    s_add_u32 s33, s33, s56
    s_lshl_b32 s43, 1, s33
    s_lshl_b32 s53, 4, s33
    s_lshl_b32 s32, s32, 15
    s_lshl_b32 s33, s28, 12
    s_add_u32 s32, s32, s33
    s_lshl_b32 s33, s38, 14
    s_add_u32 s54, s32, s33
    s_xor_b32 s33, s33, 16384
    s_add_u32 s55, s32, s33
    v_lshlrev_b32 v34, 4, v2
    v_mov_b32 v4, 1073758208
    v_mov_b32 v5, 1073758208
    v_mov_b32 v6, 1073758208
    v_mov_b32 v7, 1073758208
    v_mov_b32 v32, s43
    v_mov_b32 v33, s53
    s_add_u32 m0, s29, 4096
    s_add_u32 s32, s44, 1048576
    buffer_load_dwordx4 v15, s[12:15], s32 offen  lds
    buffer_load_dwordx4 v16, s[12:15], s32 offen offset:1024  lds
    buffer_load_dwordx4 v17, s[12:15], s32 offen offset:2048  lds
    buffer_load_dwordx4 v18, s[12:15], s32 offen offset:3072  lds
    v_mov_b32 v128, 0
    v_mov_b32 v129, 0
    v_mov_b32 v130, 0
    v_mov_b32 v131, 0
    v_mov_b32 v132, 0
    v_mov_b32 v133, 0
    v_mov_b32 v134, 0
    v_mov_b32 v135, 0
    v_mov_b32 v136, 0
    v_mov_b32 v137, 0
    v_mov_b32 v138, 0
    v_mov_b32 v139, 0
    v_mov_b32 v140, 0
    v_mov_b32 v141, 0
    v_mov_b32 v142, 0
    v_mov_b32 v143, 0
    v_mov_b32 v144, 0
    v_mov_b32 v145, 0
    v_mov_b32 v146, 0
    v_mov_b32 v147, 0
    v_mov_b32 v148, 0
    v_mov_b32 v149, 0
    v_mov_b32 v150, 0
    v_mov_b32 v151, 0
    v_mov_b32 v152, 0
    v_mov_b32 v153, 0
    v_mov_b32 v154, 0
    v_mov_b32 v155, 0
    v_mov_b32 v156, 0
    v_mov_b32 v157, 0
    v_mov_b32 v158, 0
    v_mov_b32 v159, 0
    s_add_u32 m0, s29, 8192
    s_add_u32 s32, s44, 2097152
    buffer_load_dwordx4 v15, s[12:15], s32 offen  lds
    buffer_load_dwordx4 v16, s[12:15], s32 offen offset:1024  lds
    buffer_load_dwordx4 v17, s[12:15], s32 offen offset:2048  lds
    buffer_load_dwordx4 v18, s[12:15], s32 offen offset:3072  lds
    v_mov_b32 v160, 0
    v_mov_b32 v161, 0
    v_mov_b32 v162, 0
    v_mov_b32 v163, 0
    v_mov_b32 v164, 0
    v_mov_b32 v165, 0
    v_mov_b32 v166, 0
    v_mov_b32 v167, 0
    v_mov_b32 v168, 0
    v_mov_b32 v169, 0
    v_mov_b32 v170, 0
    v_mov_b32 v171, 0
    v_mov_b32 v172, 0
    v_mov_b32 v173, 0
    v_mov_b32 v174, 0
    v_mov_b32 v175, 0
    v_mov_b32 v176, 0
    v_mov_b32 v177, 0
    v_mov_b32 v178, 0
    v_mov_b32 v179, 0
    v_mov_b32 v180, 0
    v_mov_b32 v181, 0
    v_mov_b32 v182, 0
    v_mov_b32 v183, 0
    v_mov_b32 v184, 0
    v_mov_b32 v185, 0
    v_mov_b32 v186, 0
    v_mov_b32 v187, 0
    v_mov_b32 v188, 0
    v_mov_b32 v189, 0
    v_mov_b32 v190, 0
    v_mov_b32 v191, 0
    s_add_u32 m0, s29, 12288
    s_add_u32 s32, s44, 3145728
    buffer_load_dwordx4 v15, s[12:15], s32 offen  lds
    buffer_load_dwordx4 v16, s[12:15], s32 offen offset:1024  lds
    buffer_load_dwordx4 v17, s[12:15], s32 offen offset:2048  lds
    buffer_load_dwordx4 v18, s[12:15], s32 offen offset:3072  lds
    v_mov_b32 v192, 0
    v_mov_b32 v193, 0
    v_mov_b32 v194, 0
    v_mov_b32 v195, 0
    v_mov_b32 v196, 0
    v_mov_b32 v197, 0
    v_mov_b32 v198, 0
    v_mov_b32 v199, 0
    v_mov_b32 v200, 0
    v_mov_b32 v201, 0
    v_mov_b32 v202, 0
    v_mov_b32 v203, 0
    v_mov_b32 v204, 0
    v_mov_b32 v205, 0
    v_mov_b32 v206, 0
    v_mov_b32 v207, 0
    v_mov_b32 v208, 0
    v_mov_b32 v209, 0
    v_mov_b32 v210, 0
    v_mov_b32 v211, 0
    v_mov_b32 v212, 0
    v_mov_b32 v213, 0
    v_mov_b32 v214, 0
    v_mov_b32 v215, 0
    v_mov_b32 v216, 0
    v_mov_b32 v217, 0
    v_mov_b32 v218, 0
    v_mov_b32 v219, 0
    v_mov_b32 v220, 0
    v_mov_b32 v221, 0
    v_mov_b32 v222, 0
    v_mov_b32 v223, 0
    s_add_u32 m0, s29, 16384
    s_add_u32 s32, s44, 4194304
    buffer_load_dwordx4 v15, s[12:15], s32 offen  lds
    buffer_load_dwordx4 v16, s[12:15], s32 offen offset:1024  lds
    buffer_load_dwordx4 v17, s[12:15], s32 offen offset:2048  lds
    buffer_load_dwordx4 v18, s[12:15], s32 offen offset:3072  lds
    v_mov_b32 v224, 0
    v_mov_b32 v225, 0
    v_mov_b32 v226, 0
    v_mov_b32 v227, 0
    v_mov_b32 v228, 0
    v_mov_b32 v229, 0
    v_mov_b32 v230, 0
    v_mov_b32 v231, 0
    v_mov_b32 v232, 0
    v_mov_b32 v233, 0
    v_mov_b32 v234, 0
    v_mov_b32 v235, 0
    v_mov_b32 v236, 0
    v_mov_b32 v237, 0
    v_mov_b32 v238, 0
    v_mov_b32 v239, 0
    v_mov_b32 v240, 0
    v_mov_b32 v241, 0
    v_mov_b32 v242, 0
    v_mov_b32 v243, 0
    v_mov_b32 v244, 0
    v_mov_b32 v245, 0
    v_mov_b32 v246, 0
    v_mov_b32 v247, 0
    v_mov_b32 v248, 0
    v_mov_b32 v249, 0
    v_mov_b32 v250, 0
    v_mov_b32 v251, 0
    v_mov_b32 v252, 0
    v_mov_b32 v253, 0
    v_mov_b32 v254, 0
    v_mov_b32 v255, 0
    s_waitcnt vmcnt(20)
    s_barrier
    ds_read_b128 v[84:87], v8 offset:0
    ds_read_b128 v[88:91], v8 offset:4608
    ds_read_b128 v[92:95], v8 offset:9216
    ds_read_b128 v[96:99], v8 offset:13824
    ds_read_b128 v[100:103], v8 offset:18432
    ds_read_b128 v[104:107], v8 offset:23040
    s_waitcnt lgkmcnt(5)
    s_waitcnt vmcnt(16)
    ds_read_b64_tr_b16 v[36:37], v11 offset:0
    ds_read_b64_tr_b16 v[38:39], v11 offset:512
    ds_read_b64_tr_b16 v[40:41], v12 offset:0
    ds_read_b64_tr_b16 v[42:43], v12 offset:512
    ds_read_b64_tr_b16 v[44:45], v13 offset:0
    ds_read_b64_tr_b16 v[46:47], v13 offset:512
    ds_read_b64_tr_b16 v[48:49], v14 offset:0
    ds_read_b64_tr_b16 v[50:51], v14 offset:512
    ds_read_b128 v[108:111], v8 offset:27648
    ds_read_b128 v[112:115], v8 offset:32256
    ds_read_b128 v[116:119], v9 offset:0
    ds_read_b128 v[120:123], v9 offset:4608
    s_waitcnt lgkmcnt(10)
    v_mfma_f32_16x16x32_bf16 v[128:131], v[36:39], v[84:87], v[128:131]
    s_waitcnt lgkmcnt(4)
    s_add_u32 m0, s29, 0
    s_add_u32 s32, s44, 5242880
    buffer_load_dwordx4 v15, s[12:15], s32 offen  lds
    v_mfma_f32_16x16x32_bf16 v[132:135], v[40:43], v[84:87], v[132:135]
    v_mfma_f32_16x16x32_bf16 v[136:139], v[44:47], v[84:87], v[136:139]
    buffer_load_dwordx4 v16, s[12:15], s32 offen offset:1024  lds
    v_mfma_f32_16x16x32_bf16 v[140:143], v[48:51], v[84:87], v[140:143]
    v_mfma_f32_16x16x32_bf16 v[144:147], v[36:39], v[88:91], v[144:147]
    buffer_load_dwordx4 v17, s[12:15], s32 offen offset:2048  lds
    v_mfma_f32_16x16x32_bf16 v[148:151], v[40:43], v[88:91], v[148:151]
    v_mfma_f32_16x16x32_bf16 v[152:155], v[44:47], v[88:91], v[152:155]
    buffer_load_dwordx4 v18, s[12:15], s32 offen offset:3072  lds
    v_mfma_f32_16x16x32_bf16 v[156:159], v[48:51], v[88:91], v[156:159]
    v_mfma_f32_16x16x32_bf16 v[160:163], v[36:39], v[92:95], v[160:163]
    s_waitcnt vmcnt(16)
    ds_read_b64_tr_b16 v[52:53], v11 offset:4096
    v_mfma_f32_16x16x32_bf16 v[164:167], v[40:43], v[92:95], v[164:167]
    v_mfma_f32_16x16x32_bf16 v[168:171], v[44:47], v[92:95], v[168:171]
    ds_read_b64_tr_b16 v[54:55], v11 offset:4608
    v_mfma_f32_16x16x32_bf16 v[172:175], v[48:51], v[92:95], v[172:175]
    v_mfma_f32_16x16x32_bf16 v[176:179], v[36:39], v[96:99], v[176:179]
    ds_read_b64_tr_b16 v[56:57], v12 offset:4096
    v_mfma_f32_16x16x32_bf16 v[180:183], v[40:43], v[96:99], v[180:183]
    v_mfma_f32_16x16x32_bf16 v[184:187], v[44:47], v[96:99], v[184:187]
    ds_read_b64_tr_b16 v[58:59], v12 offset:4608
    v_mfma_f32_16x16x32_bf16 v[188:191], v[48:51], v[96:99], v[188:191]
    v_mfma_f32_16x16x32_bf16 v[192:195], v[36:39], v[100:103], v[192:195]
    ds_read_b64_tr_b16 v[60:61], v13 offset:4096
    v_mfma_f32_16x16x32_bf16 v[196:199], v[40:43], v[100:103], v[196:199]
    v_mfma_f32_16x16x32_bf16 v[200:203], v[44:47], v[100:103], v[200:203]
    ds_read_b64_tr_b16 v[62:63], v13 offset:4608
    v_mfma_f32_16x16x32_bf16 v[204:207], v[48:51], v[100:103], v[204:207]
    v_mfma_f32_16x16x32_bf16 v[208:211], v[36:39], v[104:107], v[208:211]
    ds_read_b64_tr_b16 v[64:65], v14 offset:4096
    v_mfma_f32_16x16x32_bf16 v[212:215], v[40:43], v[104:107], v[212:215]
    v_mfma_f32_16x16x32_bf16 v[216:219], v[44:47], v[104:107], v[216:219]
    ds_read_b64_tr_b16 v[66:67], v14 offset:4608
    v_mfma_f32_16x16x32_bf16 v[220:223], v[48:51], v[104:107], v[220:223]
    s_waitcnt lgkmcnt(11)
    v_mfma_f32_16x16x32_bf16 v[224:227], v[36:39], v[108:111], v[224:227]
    v_mfma_f32_16x16x32_bf16 v[228:231], v[40:43], v[108:111], v[228:231]
    v_mfma_f32_16x16x32_bf16 v[232:235], v[44:47], v[108:111], v[232:235]
    ds_read_b128 v[124:127], v9 offset:9216
    v_mfma_f32_16x16x32_bf16 v[236:239], v[48:51], v[108:111], v[236:239]
    s_waitcnt lgkmcnt(11)
    v_mfma_f32_16x16x32_bf16 v[240:243], v[36:39], v[112:115], v[240:243]
    v_mfma_f32_16x16x32_bf16 v[244:247], v[40:43], v[112:115], v[244:247]
    v_mfma_f32_16x16x32_bf16 v[248:251], v[44:47], v[112:115], v[248:251]
    v_mfma_f32_16x16x32_bf16 v[252:255], v[48:51], v[112:115], v[252:255]
    s_waitcnt lgkmcnt(7)
    v_mfma_f32_16x16x32_bf16 v[128:131], v[52:55], v[88:91], v[128:131]
    s_waitcnt lgkmcnt(1)
    s_add_u32 m0, s29, 4096
    s_add_u32 s32, s44, 6291456
    buffer_load_dwordx4 v15, s[12:15], s32 offen  lds
    v_mfma_f32_16x16x32_bf16 v[132:135], v[56:59], v[88:91], v[132:135]
    v_mfma_f32_16x16x32_bf16 v[136:139], v[60:63], v[88:91], v[136:139]
    buffer_load_dwordx4 v16, s[12:15], s32 offen offset:1024  lds
    v_mfma_f32_16x16x32_bf16 v[140:143], v[64:67], v[88:91], v[140:143]
    v_mfma_f32_16x16x32_bf16 v[144:147], v[52:55], v[92:95], v[144:147]
    buffer_load_dwordx4 v17, s[12:15], s32 offen offset:2048  lds
    v_mfma_f32_16x16x32_bf16 v[148:151], v[56:59], v[92:95], v[148:151]
    v_mfma_f32_16x16x32_bf16 v[152:155], v[60:63], v[92:95], v[152:155]
    buffer_load_dwordx4 v18, s[12:15], s32 offen offset:3072  lds
    v_mfma_f32_16x16x32_bf16 v[156:159], v[64:67], v[92:95], v[156:159]
    v_mfma_f32_16x16x32_bf16 v[160:163], v[52:55], v[96:99], v[160:163]
    s_waitcnt vmcnt(16)
    ds_read_b64_tr_b16 v[68:69], v11 offset:8192
    v_mfma_f32_16x16x32_bf16 v[164:167], v[56:59], v[96:99], v[164:167]
    v_mfma_f32_16x16x32_bf16 v[168:171], v[60:63], v[96:99], v[168:171]
    ds_read_b64_tr_b16 v[70:71], v11 offset:8704
    v_mfma_f32_16x16x32_bf16 v[172:175], v[64:67], v[96:99], v[172:175]
    v_mfma_f32_16x16x32_bf16 v[176:179], v[52:55], v[100:103], v[176:179]
    ds_read_b64_tr_b16 v[72:73], v12 offset:8192
    v_mfma_f32_16x16x32_bf16 v[180:183], v[56:59], v[100:103], v[180:183]
    v_mfma_f32_16x16x32_bf16 v[184:187], v[60:63], v[100:103], v[184:187]
    ds_read_b64_tr_b16 v[74:75], v12 offset:8704
    v_mfma_f32_16x16x32_bf16 v[188:191], v[64:67], v[100:103], v[188:191]
    v_mfma_f32_16x16x32_bf16 v[192:195], v[52:55], v[104:107], v[192:195]
    ds_read_b64_tr_b16 v[76:77], v13 offset:8192
    v_mfma_f32_16x16x32_bf16 v[196:199], v[56:59], v[104:107], v[196:199]
    v_mfma_f32_16x16x32_bf16 v[200:203], v[60:63], v[104:107], v[200:203]
    ds_read_b64_tr_b16 v[78:79], v13 offset:8704
    v_mfma_f32_16x16x32_bf16 v[204:207], v[64:67], v[104:107], v[204:207]
    v_mfma_f32_16x16x32_bf16 v[208:211], v[52:55], v[108:111], v[208:211]
    ds_read_b64_tr_b16 v[80:81], v14 offset:8192
    v_mfma_f32_16x16x32_bf16 v[212:215], v[56:59], v[108:111], v[212:215]
    v_mfma_f32_16x16x32_bf16 v[216:219], v[60:63], v[108:111], v[216:219]
    ds_read_b64_tr_b16 v[82:83], v14 offset:8704
    v_mfma_f32_16x16x32_bf16 v[220:223], v[64:67], v[108:111], v[220:223]
    v_mfma_f32_16x16x32_bf16 v[224:227], v[52:55], v[112:115], v[224:227]
    v_mfma_f32_16x16x32_bf16 v[228:231], v[56:59], v[112:115], v[228:231]
    v_mfma_f32_16x16x32_bf16 v[232:235], v[60:63], v[112:115], v[232:235]
    ds_read_b128 v[84:87], v9 offset:13824
    v_mfma_f32_16x16x32_bf16 v[236:239], v[64:67], v[112:115], v[236:239]
    v_mfma_f32_16x16x32_bf16 v[240:243], v[52:55], v[116:119], v[240:243]
    v_mfma_f32_16x16x32_bf16 v[244:247], v[56:59], v[116:119], v[244:247]
    v_mfma_f32_16x16x32_bf16 v[248:251], v[60:63], v[116:119], v[248:251]
    v_mfma_f32_16x16x32_bf16 v[252:255], v[64:67], v[116:119], v[252:255]
    s_waitcnt lgkmcnt(7)
    v_mfma_f32_16x16x32_bf16 v[128:131], v[68:71], v[92:95], v[128:131]
    s_waitcnt lgkmcnt(1)
    s_add_u32 m0, s29, 8192
    s_add_u32 s32, s44, 7340032
    buffer_load_dwordx4 v15, s[12:15], s32 offen  lds
    v_mfma_f32_16x16x32_bf16 v[132:135], v[72:75], v[92:95], v[132:135]
    v_mfma_f32_16x16x32_bf16 v[136:139], v[76:79], v[92:95], v[136:139]
    buffer_load_dwordx4 v16, s[12:15], s32 offen offset:1024  lds
    v_mfma_f32_16x16x32_bf16 v[140:143], v[80:83], v[92:95], v[140:143]
    v_mfma_f32_16x16x32_bf16 v[144:147], v[68:71], v[96:99], v[144:147]
    buffer_load_dwordx4 v17, s[12:15], s32 offen offset:2048  lds
    v_mfma_f32_16x16x32_bf16 v[148:151], v[72:75], v[96:99], v[148:151]
    v_mfma_f32_16x16x32_bf16 v[152:155], v[76:79], v[96:99], v[152:155]
    buffer_load_dwordx4 v18, s[12:15], s32 offen offset:3072  lds
    v_mfma_f32_16x16x32_bf16 v[156:159], v[80:83], v[96:99], v[156:159]
    v_mfma_f32_16x16x32_bf16 v[160:163], v[68:71], v[100:103], v[160:163]
    s_waitcnt vmcnt(16)
    ds_read_b64_tr_b16 v[36:37], v11 offset:12288
    v_mfma_f32_16x16x32_bf16 v[164:167], v[72:75], v[100:103], v[164:167]
    v_mfma_f32_16x16x32_bf16 v[168:171], v[76:79], v[100:103], v[168:171]
    ds_read_b64_tr_b16 v[38:39], v11 offset:12800
    v_mfma_f32_16x16x32_bf16 v[172:175], v[80:83], v[100:103], v[172:175]
    v_mfma_f32_16x16x32_bf16 v[176:179], v[68:71], v[104:107], v[176:179]
    ds_read_b64_tr_b16 v[40:41], v12 offset:12288
    v_mfma_f32_16x16x32_bf16 v[180:183], v[72:75], v[104:107], v[180:183]
    v_mfma_f32_16x16x32_bf16 v[184:187], v[76:79], v[104:107], v[184:187]
    ds_read_b64_tr_b16 v[42:43], v12 offset:12800
    v_mfma_f32_16x16x32_bf16 v[188:191], v[80:83], v[104:107], v[188:191]
    v_mfma_f32_16x16x32_bf16 v[192:195], v[68:71], v[108:111], v[192:195]
    ds_read_b64_tr_b16 v[44:45], v13 offset:12288
    v_mfma_f32_16x16x32_bf16 v[196:199], v[72:75], v[108:111], v[196:199]
    v_mfma_f32_16x16x32_bf16 v[200:203], v[76:79], v[108:111], v[200:203]
    ds_read_b64_tr_b16 v[46:47], v13 offset:12800
    v_mfma_f32_16x16x32_bf16 v[204:207], v[80:83], v[108:111], v[204:207]
    v_mfma_f32_16x16x32_bf16 v[208:211], v[68:71], v[112:115], v[208:211]
    ds_read_b64_tr_b16 v[48:49], v14 offset:12288
    v_mfma_f32_16x16x32_bf16 v[212:215], v[72:75], v[112:115], v[212:215]
    v_mfma_f32_16x16x32_bf16 v[216:219], v[76:79], v[112:115], v[216:219]
    ds_read_b64_tr_b16 v[50:51], v14 offset:12800
    v_mfma_f32_16x16x32_bf16 v[220:223], v[80:83], v[112:115], v[220:223]
    v_mfma_f32_16x16x32_bf16 v[224:227], v[68:71], v[116:119], v[224:227]
    v_mfma_f32_16x16x32_bf16 v[228:231], v[72:75], v[116:119], v[228:231]
    v_mfma_f32_16x16x32_bf16 v[232:235], v[76:79], v[116:119], v[232:235]
    ds_read_b128 v[88:91], v9 offset:18432
    v_mfma_f32_16x16x32_bf16 v[236:239], v[80:83], v[116:119], v[236:239]
    v_mfma_f32_16x16x32_bf16 v[240:243], v[68:71], v[120:123], v[240:243]
    v_mfma_f32_16x16x32_bf16 v[244:247], v[72:75], v[120:123], v[244:247]
    v_mfma_f32_16x16x32_bf16 v[248:251], v[76:79], v[120:123], v[248:251]
    v_mfma_f32_16x16x32_bf16 v[252:255], v[80:83], v[120:123], v[252:255]
    s_waitcnt lgkmcnt(7)
    v_mfma_f32_16x16x32_bf16 v[128:131], v[36:39], v[96:99], v[128:131]
    s_waitcnt lgkmcnt(1)
    s_add_u32 m0, s29, 12288
    s_add_u32 s32, s44, 8388608
    buffer_load_dwordx4 v15, s[12:15], s32 offen  lds
    v_mfma_f32_16x16x32_bf16 v[132:135], v[40:43], v[96:99], v[132:135]
    v_mfma_f32_16x16x32_bf16 v[136:139], v[44:47], v[96:99], v[136:139]
    buffer_load_dwordx4 v16, s[12:15], s32 offen offset:1024  lds
    v_mfma_f32_16x16x32_bf16 v[140:143], v[48:51], v[96:99], v[140:143]
    v_mfma_f32_16x16x32_bf16 v[144:147], v[36:39], v[100:103], v[144:147]
    buffer_load_dwordx4 v17, s[12:15], s32 offen offset:2048  lds
    v_mfma_f32_16x16x32_bf16 v[148:151], v[40:43], v[100:103], v[148:151]
    v_mfma_f32_16x16x32_bf16 v[152:155], v[44:47], v[100:103], v[152:155]
    buffer_load_dwordx4 v18, s[12:15], s32 offen offset:3072  lds
    v_mfma_f32_16x16x32_bf16 v[156:159], v[48:51], v[100:103], v[156:159]
    v_mfma_f32_16x16x32_bf16 v[160:163], v[36:39], v[104:107], v[160:163]
    s_waitcnt vmcnt(16)
    ds_read_b64_tr_b16 v[52:53], v11 offset:16384
    v_mfma_f32_16x16x32_bf16 v[164:167], v[40:43], v[104:107], v[164:167]
    v_mfma_f32_16x16x32_bf16 v[168:171], v[44:47], v[104:107], v[168:171]
    ds_read_b64_tr_b16 v[54:55], v11 offset:16896
    v_mfma_f32_16x16x32_bf16 v[172:175], v[48:51], v[104:107], v[172:175]
    v_mfma_f32_16x16x32_bf16 v[176:179], v[36:39], v[108:111], v[176:179]
    ds_read_b64_tr_b16 v[56:57], v12 offset:16384
    v_mfma_f32_16x16x32_bf16 v[180:183], v[40:43], v[108:111], v[180:183]
    v_mfma_f32_16x16x32_bf16 v[184:187], v[44:47], v[108:111], v[184:187]
    ds_read_b64_tr_b16 v[58:59], v12 offset:16896
    v_mfma_f32_16x16x32_bf16 v[188:191], v[48:51], v[108:111], v[188:191]
    v_mfma_f32_16x16x32_bf16 v[192:195], v[36:39], v[112:115], v[192:195]
    ds_read_b64_tr_b16 v[60:61], v13 offset:16384
    v_mfma_f32_16x16x32_bf16 v[196:199], v[40:43], v[112:115], v[196:199]
    v_mfma_f32_16x16x32_bf16 v[200:203], v[44:47], v[112:115], v[200:203]
    ds_read_b64_tr_b16 v[62:63], v13 offset:16896
    v_mfma_f32_16x16x32_bf16 v[204:207], v[48:51], v[112:115], v[204:207]
    v_mfma_f32_16x16x32_bf16 v[208:211], v[36:39], v[116:119], v[208:211]
    ds_read_b64_tr_b16 v[64:65], v14 offset:16384
    v_mfma_f32_16x16x32_bf16 v[212:215], v[40:43], v[116:119], v[212:215]
    v_mfma_f32_16x16x32_bf16 v[216:219], v[44:47], v[116:119], v[216:219]
    ds_read_b64_tr_b16 v[66:67], v14 offset:16896
    v_mfma_f32_16x16x32_bf16 v[220:223], v[48:51], v[116:119], v[220:223]
    v_mfma_f32_16x16x32_bf16 v[224:227], v[36:39], v[120:123], v[224:227]
    v_mfma_f32_16x16x32_bf16 v[228:231], v[40:43], v[120:123], v[228:231]
    v_mfma_f32_16x16x32_bf16 v[232:235], v[44:47], v[120:123], v[232:235]
    ds_read_b128 v[92:95], v9 offset:23040
    v_mfma_f32_16x16x32_bf16 v[236:239], v[48:51], v[120:123], v[236:239]
    v_mfma_f32_16x16x32_bf16 v[240:243], v[36:39], v[124:127], v[240:243]
    v_mfma_f32_16x16x32_bf16 v[244:247], v[40:43], v[124:127], v[244:247]
    v_mfma_f32_16x16x32_bf16 v[248:251], v[44:47], v[124:127], v[248:251]
    v_mfma_f32_16x16x32_bf16 v[252:255], v[48:51], v[124:127], v[252:255]
    s_waitcnt lgkmcnt(7)
    v_mfma_f32_16x16x32_bf16 v[128:131], v[52:55], v[100:103], v[128:131]
    s_waitcnt lgkmcnt(1)
    s_add_u32 m0, s29, 16384
    s_add_u32 s32, s44, 9437184
    buffer_load_dwordx4 v15, s[12:15], s32 offen  lds
    v_mfma_f32_16x16x32_bf16 v[132:135], v[56:59], v[100:103], v[132:135]
    v_mfma_f32_16x16x32_bf16 v[136:139], v[60:63], v[100:103], v[136:139]
    buffer_load_dwordx4 v16, s[12:15], s32 offen offset:1024  lds
    v_mfma_f32_16x16x32_bf16 v[140:143], v[64:67], v[100:103], v[140:143]
    v_mfma_f32_16x16x32_bf16 v[144:147], v[52:55], v[104:107], v[144:147]
    buffer_load_dwordx4 v17, s[12:15], s32 offen offset:2048  lds
    v_mfma_f32_16x16x32_bf16 v[148:151], v[56:59], v[104:107], v[148:151]
    v_mfma_f32_16x16x32_bf16 v[152:155], v[60:63], v[104:107], v[152:155]
    buffer_load_dwordx4 v18, s[12:15], s32 offen offset:3072  lds
    v_mfma_f32_16x16x32_bf16 v[156:159], v[64:67], v[104:107], v[156:159]
    v_mfma_f32_16x16x32_bf16 v[160:163], v[52:55], v[108:111], v[160:163]
    s_waitcnt vmcnt(16)
    ds_read_b64_tr_b16 v[68:69], v11 offset:0
    v_mfma_f32_16x16x32_bf16 v[164:167], v[56:59], v[108:111], v[164:167]
    v_mfma_f32_16x16x32_bf16 v[168:171], v[60:63], v[108:111], v[168:171]
    ds_read_b64_tr_b16 v[70:71], v11 offset:512
    v_mfma_f32_16x16x32_bf16 v[172:175], v[64:67], v[108:111], v[172:175]
    v_mfma_f32_16x16x32_bf16 v[176:179], v[52:55], v[112:115], v[176:179]
    ds_read_b64_tr_b16 v[72:73], v12 offset:0
    v_mfma_f32_16x16x32_bf16 v[180:183], v[56:59], v[112:115], v[180:183]
    v_mfma_f32_16x16x32_bf16 v[184:187], v[60:63], v[112:115], v[184:187]
    ds_read_b64_tr_b16 v[74:75], v12 offset:512
    v_mfma_f32_16x16x32_bf16 v[188:191], v[64:67], v[112:115], v[188:191]
    v_mfma_f32_16x16x32_bf16 v[192:195], v[52:55], v[116:119], v[192:195]
    ds_read_b64_tr_b16 v[76:77], v13 offset:0
    v_mfma_f32_16x16x32_bf16 v[196:199], v[56:59], v[116:119], v[196:199]
    v_mfma_f32_16x16x32_bf16 v[200:203], v[60:63], v[116:119], v[200:203]
    ds_read_b64_tr_b16 v[78:79], v13 offset:512
    v_mfma_f32_16x16x32_bf16 v[204:207], v[64:67], v[116:119], v[204:207]
    v_mfma_f32_16x16x32_bf16 v[208:211], v[52:55], v[120:123], v[208:211]
    ds_read_b64_tr_b16 v[80:81], v14 offset:0
    v_mfma_f32_16x16x32_bf16 v[212:215], v[56:59], v[120:123], v[212:215]
    v_mfma_f32_16x16x32_bf16 v[216:219], v[60:63], v[120:123], v[216:219]
    ds_read_b64_tr_b16 v[82:83], v14 offset:512
    v_mfma_f32_16x16x32_bf16 v[220:223], v[64:67], v[120:123], v[220:223]
    v_mfma_f32_16x16x32_bf16 v[224:227], v[52:55], v[124:127], v[224:227]
    v_mfma_f32_16x16x32_bf16 v[228:231], v[56:59], v[124:127], v[228:231]
    v_mfma_f32_16x16x32_bf16 v[232:235], v[60:63], v[124:127], v[232:235]
    ds_read_b128 v[96:99], v9 offset:27648
    v_mfma_f32_16x16x32_bf16 v[236:239], v[64:67], v[124:127], v[236:239]
    v_mfma_f32_16x16x32_bf16 v[240:243], v[52:55], v[84:87], v[240:243]
    v_mfma_f32_16x16x32_bf16 v[244:247], v[56:59], v[84:87], v[244:247]
    v_mfma_f32_16x16x32_bf16 v[248:251], v[60:63], v[84:87], v[248:251]
    v_mfma_f32_16x16x32_bf16 v[252:255], v[64:67], v[84:87], v[252:255]
    s_waitcnt lgkmcnt(7)
    v_mfma_f32_16x16x32_bf16 v[128:131], v[68:71], v[104:107], v[128:131]
    s_waitcnt lgkmcnt(1)
    s_add_u32 m0, s29, 0
    s_add_u32 s32, s44, 10485760
    buffer_load_dwordx4 v15, s[12:15], s32 offen  lds
    v_mfma_f32_16x16x32_bf16 v[132:135], v[72:75], v[104:107], v[132:135]
    v_mfma_f32_16x16x32_bf16 v[136:139], v[76:79], v[104:107], v[136:139]
    buffer_load_dwordx4 v16, s[12:15], s32 offen offset:1024  lds
    v_mfma_f32_16x16x32_bf16 v[140:143], v[80:83], v[104:107], v[140:143]
    v_mfma_f32_16x16x32_bf16 v[144:147], v[68:71], v[108:111], v[144:147]
    buffer_load_dwordx4 v17, s[12:15], s32 offen offset:2048  lds
    v_mfma_f32_16x16x32_bf16 v[148:151], v[72:75], v[108:111], v[148:151]
    v_mfma_f32_16x16x32_bf16 v[152:155], v[76:79], v[108:111], v[152:155]
    buffer_load_dwordx4 v18, s[12:15], s32 offen offset:3072  lds
    v_mfma_f32_16x16x32_bf16 v[156:159], v[80:83], v[108:111], v[156:159]
    v_mfma_f32_16x16x32_bf16 v[160:163], v[68:71], v[112:115], v[160:163]
    s_waitcnt vmcnt(16)
    ds_read_b64_tr_b16 v[36:37], v11 offset:4096
    v_mfma_f32_16x16x32_bf16 v[164:167], v[72:75], v[112:115], v[164:167]
    v_mfma_f32_16x16x32_bf16 v[168:171], v[76:79], v[112:115], v[168:171]
    ds_read_b64_tr_b16 v[38:39], v11 offset:4608
    v_mfma_f32_16x16x32_bf16 v[172:175], v[80:83], v[112:115], v[172:175]
    v_mfma_f32_16x16x32_bf16 v[176:179], v[68:71], v[116:119], v[176:179]
    ds_read_b64_tr_b16 v[40:41], v12 offset:4096
    v_mfma_f32_16x16x32_bf16 v[180:183], v[72:75], v[116:119], v[180:183]
    v_mfma_f32_16x16x32_bf16 v[184:187], v[76:79], v[116:119], v[184:187]
    ds_read_b64_tr_b16 v[42:43], v12 offset:4608
    v_mfma_f32_16x16x32_bf16 v[188:191], v[80:83], v[116:119], v[188:191]
    v_mfma_f32_16x16x32_bf16 v[192:195], v[68:71], v[120:123], v[192:195]
    ds_read_b64_tr_b16 v[44:45], v13 offset:4096
    v_mfma_f32_16x16x32_bf16 v[196:199], v[72:75], v[120:123], v[196:199]
    v_mfma_f32_16x16x32_bf16 v[200:203], v[76:79], v[120:123], v[200:203]
    ds_read_b64_tr_b16 v[46:47], v13 offset:4608
    v_mfma_f32_16x16x32_bf16 v[204:207], v[80:83], v[120:123], v[204:207]
    v_mfma_f32_16x16x32_bf16 v[208:211], v[68:71], v[124:127], v[208:211]
    ds_read_b64_tr_b16 v[48:49], v14 offset:4096
    v_mfma_f32_16x16x32_bf16 v[212:215], v[72:75], v[124:127], v[212:215]
    v_mfma_f32_16x16x32_bf16 v[216:219], v[76:79], v[124:127], v[216:219]
    ds_read_b64_tr_b16 v[50:51], v14 offset:4608
    v_mfma_f32_16x16x32_bf16 v[220:223], v[80:83], v[124:127], v[220:223]
    v_mfma_f32_16x16x32_bf16 v[224:227], v[68:71], v[84:87], v[224:227]
    v_mfma_f32_16x16x32_bf16 v[228:231], v[72:75], v[84:87], v[228:231]
    v_mfma_f32_16x16x32_bf16 v[232:235], v[76:79], v[84:87], v[232:235]
    ds_read_b128 v[100:103], v9 offset:32256
    v_mfma_f32_16x16x32_bf16 v[236:239], v[80:83], v[84:87], v[236:239]
    v_mfma_f32_16x16x32_bf16 v[240:243], v[68:71], v[88:91], v[240:243]
    v_mfma_f32_16x16x32_bf16 v[244:247], v[72:75], v[88:91], v[244:247]
    v_mfma_f32_16x16x32_bf16 v[248:251], v[76:79], v[88:91], v[248:251]
    v_mfma_f32_16x16x32_bf16 v[252:255], v[80:83], v[88:91], v[252:255]
    s_waitcnt lgkmcnt(7)
    v_mfma_f32_16x16x32_bf16 v[128:131], v[36:39], v[108:111], v[128:131]
    s_waitcnt lgkmcnt(1)
    s_add_u32 m0, s29, 4096
    s_add_u32 s32, s44, 11534336
    buffer_load_dwordx4 v15, s[12:15], s32 offen  lds
    v_mfma_f32_16x16x32_bf16 v[132:135], v[40:43], v[108:111], v[132:135]
    v_mfma_f32_16x16x32_bf16 v[136:139], v[44:47], v[108:111], v[136:139]
    buffer_load_dwordx4 v16, s[12:15], s32 offen offset:1024  lds
    v_mfma_f32_16x16x32_bf16 v[140:143], v[48:51], v[108:111], v[140:143]
    v_mfma_f32_16x16x32_bf16 v[144:147], v[36:39], v[112:115], v[144:147]
    buffer_load_dwordx4 v17, s[12:15], s32 offen offset:2048  lds
    v_mfma_f32_16x16x32_bf16 v[148:151], v[40:43], v[112:115], v[148:151]
    v_mfma_f32_16x16x32_bf16 v[152:155], v[44:47], v[112:115], v[152:155]
    buffer_load_dwordx4 v18, s[12:15], s32 offen offset:3072  lds
    v_mfma_f32_16x16x32_bf16 v[156:159], v[48:51], v[112:115], v[156:159]
    v_mfma_f32_16x16x32_bf16 v[160:163], v[36:39], v[116:119], v[160:163]
    s_waitcnt vmcnt(16)
    ds_read_b64_tr_b16 v[52:53], v11 offset:8192
    v_mfma_f32_16x16x32_bf16 v[164:167], v[40:43], v[116:119], v[164:167]
    v_mfma_f32_16x16x32_bf16 v[168:171], v[44:47], v[116:119], v[168:171]
    ds_read_b64_tr_b16 v[54:55], v11 offset:8704
    v_mfma_f32_16x16x32_bf16 v[172:175], v[48:51], v[116:119], v[172:175]
    v_mfma_f32_16x16x32_bf16 v[176:179], v[36:39], v[120:123], v[176:179]
    ds_read_b64_tr_b16 v[56:57], v12 offset:8192
    v_mfma_f32_16x16x32_bf16 v[180:183], v[40:43], v[120:123], v[180:183]
    v_mfma_f32_16x16x32_bf16 v[184:187], v[44:47], v[120:123], v[184:187]
    ds_read_b64_tr_b16 v[58:59], v12 offset:8704
    v_mfma_f32_16x16x32_bf16 v[188:191], v[48:51], v[120:123], v[188:191]
    v_mfma_f32_16x16x32_bf16 v[192:195], v[36:39], v[124:127], v[192:195]
    ds_read_b64_tr_b16 v[60:61], v13 offset:8192
    v_mfma_f32_16x16x32_bf16 v[196:199], v[40:43], v[124:127], v[196:199]
    v_mfma_f32_16x16x32_bf16 v[200:203], v[44:47], v[124:127], v[200:203]
    ds_read_b64_tr_b16 v[62:63], v13 offset:8704
    v_mfma_f32_16x16x32_bf16 v[204:207], v[48:51], v[124:127], v[204:207]
    v_mfma_f32_16x16x32_bf16 v[208:211], v[36:39], v[84:87], v[208:211]
    ds_read_b64_tr_b16 v[64:65], v14 offset:8192
    v_mfma_f32_16x16x32_bf16 v[212:215], v[40:43], v[84:87], v[212:215]
    v_mfma_f32_16x16x32_bf16 v[216:219], v[44:47], v[84:87], v[216:219]
    ds_read_b64_tr_b16 v[66:67], v14 offset:8704
    v_mfma_f32_16x16x32_bf16 v[220:223], v[48:51], v[84:87], v[220:223]
    v_mfma_f32_16x16x32_bf16 v[224:227], v[36:39], v[88:91], v[224:227]
    v_mfma_f32_16x16x32_bf16 v[228:231], v[40:43], v[88:91], v[228:231]
    v_mfma_f32_16x16x32_bf16 v[232:235], v[44:47], v[88:91], v[232:235]
    ds_read_b128 v[104:107], v10 offset:0
    v_mfma_f32_16x16x32_bf16 v[236:239], v[48:51], v[88:91], v[236:239]
    v_mfma_f32_16x16x32_bf16 v[240:243], v[36:39], v[92:95], v[240:243]
    v_mfma_f32_16x16x32_bf16 v[244:247], v[40:43], v[92:95], v[244:247]
    v_mfma_f32_16x16x32_bf16 v[248:251], v[44:47], v[92:95], v[248:251]
    v_mfma_f32_16x16x32_bf16 v[252:255], v[48:51], v[92:95], v[252:255]
    s_waitcnt lgkmcnt(7)
    v_mfma_f32_16x16x32_bf16 v[128:131], v[52:55], v[112:115], v[128:131]
    s_waitcnt lgkmcnt(1)
    s_add_u32 m0, s29, 8192
    s_add_u32 s32, s44, 12582912
    buffer_load_dwordx4 v15, s[12:15], s32 offen  lds
    v_mfma_f32_16x16x32_bf16 v[132:135], v[56:59], v[112:115], v[132:135]
    v_mfma_f32_16x16x32_bf16 v[136:139], v[60:63], v[112:115], v[136:139]
    buffer_load_dwordx4 v16, s[12:15], s32 offen offset:1024  lds
    v_mfma_f32_16x16x32_bf16 v[140:143], v[64:67], v[112:115], v[140:143]
    v_mfma_f32_16x16x32_bf16 v[144:147], v[52:55], v[116:119], v[144:147]
    buffer_load_dwordx4 v17, s[12:15], s32 offen offset:2048  lds
    v_mfma_f32_16x16x32_bf16 v[148:151], v[56:59], v[116:119], v[148:151]
    v_mfma_f32_16x16x32_bf16 v[152:155], v[60:63], v[116:119], v[152:155]
    buffer_load_dwordx4 v18, s[12:15], s32 offen offset:3072  lds
    v_mfma_f32_16x16x32_bf16 v[156:159], v[64:67], v[116:119], v[156:159]
    v_mfma_f32_16x16x32_bf16 v[160:163], v[52:55], v[120:123], v[160:163]
    s_waitcnt vmcnt(16)
    ds_read_b64_tr_b16 v[68:69], v11 offset:12288
    v_mfma_f32_16x16x32_bf16 v[164:167], v[56:59], v[120:123], v[164:167]
    v_mfma_f32_16x16x32_bf16 v[168:171], v[60:63], v[120:123], v[168:171]
    ds_read_b64_tr_b16 v[70:71], v11 offset:12800
    v_mfma_f32_16x16x32_bf16 v[172:175], v[64:67], v[120:123], v[172:175]
    v_mfma_f32_16x16x32_bf16 v[176:179], v[52:55], v[124:127], v[176:179]
    ds_read_b64_tr_b16 v[72:73], v12 offset:12288
    v_mfma_f32_16x16x32_bf16 v[180:183], v[56:59], v[124:127], v[180:183]
    v_mfma_f32_16x16x32_bf16 v[184:187], v[60:63], v[124:127], v[184:187]
    ds_read_b64_tr_b16 v[74:75], v12 offset:12800
    v_mfma_f32_16x16x32_bf16 v[188:191], v[64:67], v[124:127], v[188:191]
    v_mfma_f32_16x16x32_bf16 v[192:195], v[52:55], v[84:87], v[192:195]
    ds_read_b64_tr_b16 v[76:77], v13 offset:12288
    v_mfma_f32_16x16x32_bf16 v[196:199], v[56:59], v[84:87], v[196:199]
    v_mfma_f32_16x16x32_bf16 v[200:203], v[60:63], v[84:87], v[200:203]
    ds_read_b64_tr_b16 v[78:79], v13 offset:12800
    v_mfma_f32_16x16x32_bf16 v[204:207], v[64:67], v[84:87], v[204:207]
    v_mfma_f32_16x16x32_bf16 v[208:211], v[52:55], v[88:91], v[208:211]
    ds_read_b64_tr_b16 v[80:81], v14 offset:12288
    v_mfma_f32_16x16x32_bf16 v[212:215], v[56:59], v[88:91], v[212:215]
    v_mfma_f32_16x16x32_bf16 v[216:219], v[60:63], v[88:91], v[216:219]
    ds_read_b64_tr_b16 v[82:83], v14 offset:12800
    v_mfma_f32_16x16x32_bf16 v[220:223], v[64:67], v[88:91], v[220:223]
    v_mfma_f32_16x16x32_bf16 v[224:227], v[52:55], v[92:95], v[224:227]
    v_mfma_f32_16x16x32_bf16 v[228:231], v[56:59], v[92:95], v[228:231]
    v_mfma_f32_16x16x32_bf16 v[232:235], v[60:63], v[92:95], v[232:235]
    ds_read_b128 v[108:111], v10 offset:4608
    v_mfma_f32_16x16x32_bf16 v[236:239], v[64:67], v[92:95], v[236:239]
    v_mfma_f32_16x16x32_bf16 v[240:243], v[52:55], v[96:99], v[240:243]
    v_mfma_f32_16x16x32_bf16 v[244:247], v[56:59], v[96:99], v[244:247]
    v_mfma_f32_16x16x32_bf16 v[248:251], v[60:63], v[96:99], v[248:251]
    v_mfma_f32_16x16x32_bf16 v[252:255], v[64:67], v[96:99], v[252:255]
    s_waitcnt lgkmcnt(7)
    v_mfma_f32_16x16x32_bf16 v[128:131], v[68:71], v[116:119], v[128:131]
    s_waitcnt lgkmcnt(1)
    s_add_u32 m0, s29, 12288
    s_add_u32 s32, s44, 13631488
    buffer_load_dwordx4 v15, s[12:15], s32 offen  lds
    v_mfma_f32_16x16x32_bf16 v[132:135], v[72:75], v[116:119], v[132:135]
    v_mfma_f32_16x16x32_bf16 v[136:139], v[76:79], v[116:119], v[136:139]
    buffer_load_dwordx4 v16, s[12:15], s32 offen offset:1024  lds
    v_mfma_f32_16x16x32_bf16 v[140:143], v[80:83], v[116:119], v[140:143]
    v_mfma_f32_16x16x32_bf16 v[144:147], v[68:71], v[120:123], v[144:147]
    buffer_load_dwordx4 v17, s[12:15], s32 offen offset:2048  lds
    v_mfma_f32_16x16x32_bf16 v[148:151], v[72:75], v[120:123], v[148:151]
    v_mfma_f32_16x16x32_bf16 v[152:155], v[76:79], v[120:123], v[152:155]
    buffer_load_dwordx4 v18, s[12:15], s32 offen offset:3072  lds
    v_mfma_f32_16x16x32_bf16 v[156:159], v[80:83], v[120:123], v[156:159]
    v_mfma_f32_16x16x32_bf16 v[160:163], v[68:71], v[124:127], v[160:163]
    s_waitcnt vmcnt(16)
    ds_read_b64_tr_b16 v[36:37], v11 offset:16384
    v_mfma_f32_16x16x32_bf16 v[164:167], v[72:75], v[124:127], v[164:167]
    v_mfma_f32_16x16x32_bf16 v[168:171], v[76:79], v[124:127], v[168:171]
    ds_read_b64_tr_b16 v[38:39], v11 offset:16896
    v_mfma_f32_16x16x32_bf16 v[172:175], v[80:83], v[124:127], v[172:175]
    v_mfma_f32_16x16x32_bf16 v[176:179], v[68:71], v[84:87], v[176:179]
    ds_read_b64_tr_b16 v[40:41], v12 offset:16384
    v_mfma_f32_16x16x32_bf16 v[180:183], v[72:75], v[84:87], v[180:183]
    v_mfma_f32_16x16x32_bf16 v[184:187], v[76:79], v[84:87], v[184:187]
    ds_read_b64_tr_b16 v[42:43], v12 offset:16896
    v_mfma_f32_16x16x32_bf16 v[188:191], v[80:83], v[84:87], v[188:191]
    v_mfma_f32_16x16x32_bf16 v[192:195], v[68:71], v[88:91], v[192:195]
    ds_read_b64_tr_b16 v[44:45], v13 offset:16384
    v_mfma_f32_16x16x32_bf16 v[196:199], v[72:75], v[88:91], v[196:199]
    v_mfma_f32_16x16x32_bf16 v[200:203], v[76:79], v[88:91], v[200:203]
    ds_read_b64_tr_b16 v[46:47], v13 offset:16896
    v_mfma_f32_16x16x32_bf16 v[204:207], v[80:83], v[88:91], v[204:207]
    v_mfma_f32_16x16x32_bf16 v[208:211], v[68:71], v[92:95], v[208:211]
    ds_read_b64_tr_b16 v[48:49], v14 offset:16384
    v_mfma_f32_16x16x32_bf16 v[212:215], v[72:75], v[92:95], v[212:215]
    v_mfma_f32_16x16x32_bf16 v[216:219], v[76:79], v[92:95], v[216:219]
    ds_read_b64_tr_b16 v[50:51], v14 offset:16896
    v_mfma_f32_16x16x32_bf16 v[220:223], v[80:83], v[92:95], v[220:223]
    v_mfma_f32_16x16x32_bf16 v[224:227], v[68:71], v[96:99], v[224:227]
    v_mfma_f32_16x16x32_bf16 v[228:231], v[72:75], v[96:99], v[228:231]
    v_mfma_f32_16x16x32_bf16 v[232:235], v[76:79], v[96:99], v[232:235]
    ds_read_b128 v[112:115], v10 offset:9216
    v_mfma_f32_16x16x32_bf16 v[236:239], v[80:83], v[96:99], v[236:239]
    v_mfma_f32_16x16x32_bf16 v[240:243], v[68:71], v[100:103], v[240:243]
    v_mfma_f32_16x16x32_bf16 v[244:247], v[72:75], v[100:103], v[244:247]
    v_mfma_f32_16x16x32_bf16 v[248:251], v[76:79], v[100:103], v[248:251]
    v_mfma_f32_16x16x32_bf16 v[252:255], v[80:83], v[100:103], v[252:255]
    s_waitcnt lgkmcnt(7)
    v_mfma_f32_16x16x32_bf16 v[128:131], v[36:39], v[120:123], v[128:131]
    s_waitcnt lgkmcnt(1)
    s_add_u32 m0, s29, 16384
    s_add_u32 s32, s44, 14680064
    buffer_load_dwordx4 v15, s[12:15], s32 offen  lds
    v_mfma_f32_16x16x32_bf16 v[132:135], v[40:43], v[120:123], v[132:135]
    v_mfma_f32_16x16x32_bf16 v[136:139], v[44:47], v[120:123], v[136:139]
    buffer_load_dwordx4 v16, s[12:15], s32 offen offset:1024  lds
    v_mfma_f32_16x16x32_bf16 v[140:143], v[48:51], v[120:123], v[140:143]
    v_mfma_f32_16x16x32_bf16 v[144:147], v[36:39], v[124:127], v[144:147]
    buffer_load_dwordx4 v17, s[12:15], s32 offen offset:2048  lds
    v_mfma_f32_16x16x32_bf16 v[148:151], v[40:43], v[124:127], v[148:151]
    v_mfma_f32_16x16x32_bf16 v[152:155], v[44:47], v[124:127], v[152:155]
    buffer_load_dwordx4 v18, s[12:15], s32 offen offset:3072  lds
    v_mfma_f32_16x16x32_bf16 v[156:159], v[48:51], v[124:127], v[156:159]
    v_mfma_f32_16x16x32_bf16 v[160:163], v[36:39], v[84:87], v[160:163]
    s_waitcnt vmcnt(16)
    ds_read_b64_tr_b16 v[52:53], v11 offset:0
    v_mfma_f32_16x16x32_bf16 v[164:167], v[40:43], v[84:87], v[164:167]
    v_mfma_f32_16x16x32_bf16 v[168:171], v[44:47], v[84:87], v[168:171]
    ds_read_b64_tr_b16 v[54:55], v11 offset:512
    v_mfma_f32_16x16x32_bf16 v[172:175], v[48:51], v[84:87], v[172:175]
    v_mfma_f32_16x16x32_bf16 v[176:179], v[36:39], v[88:91], v[176:179]
    ds_read_b64_tr_b16 v[56:57], v12 offset:0
    v_mfma_f32_16x16x32_bf16 v[180:183], v[40:43], v[88:91], v[180:183]
    v_mfma_f32_16x16x32_bf16 v[184:187], v[44:47], v[88:91], v[184:187]
    ds_read_b64_tr_b16 v[58:59], v12 offset:512
    v_mfma_f32_16x16x32_bf16 v[188:191], v[48:51], v[88:91], v[188:191]
    v_mfma_f32_16x16x32_bf16 v[192:195], v[36:39], v[92:95], v[192:195]
    ds_read_b64_tr_b16 v[60:61], v13 offset:0
    v_mfma_f32_16x16x32_bf16 v[196:199], v[40:43], v[92:95], v[196:199]
    v_mfma_f32_16x16x32_bf16 v[200:203], v[44:47], v[92:95], v[200:203]
    ds_read_b64_tr_b16 v[62:63], v13 offset:512
    v_mfma_f32_16x16x32_bf16 v[204:207], v[48:51], v[92:95], v[204:207]
    v_mfma_f32_16x16x32_bf16 v[208:211], v[36:39], v[96:99], v[208:211]
    ds_read_b64_tr_b16 v[64:65], v14 offset:0
    v_mfma_f32_16x16x32_bf16 v[212:215], v[40:43], v[96:99], v[212:215]
    v_mfma_f32_16x16x32_bf16 v[216:219], v[44:47], v[96:99], v[216:219]
    ds_read_b64_tr_b16 v[66:67], v14 offset:512
    v_mfma_f32_16x16x32_bf16 v[220:223], v[48:51], v[96:99], v[220:223]
    v_mfma_f32_16x16x32_bf16 v[224:227], v[36:39], v[100:103], v[224:227]
    v_mfma_f32_16x16x32_bf16 v[228:231], v[40:43], v[100:103], v[228:231]
    v_mfma_f32_16x16x32_bf16 v[232:235], v[44:47], v[100:103], v[232:235]
    ds_read_b128 v[116:119], v10 offset:13824
    v_mfma_f32_16x16x32_bf16 v[236:239], v[48:51], v[100:103], v[236:239]
    v_mfma_f32_16x16x32_bf16 v[240:243], v[36:39], v[104:107], v[240:243]
    v_mfma_f32_16x16x32_bf16 v[244:247], v[40:43], v[104:107], v[244:247]
    v_mfma_f32_16x16x32_bf16 v[248:251], v[44:47], v[104:107], v[248:251]
    v_mfma_f32_16x16x32_bf16 v[252:255], v[48:51], v[104:107], v[252:255]
    s_waitcnt lgkmcnt(7)
    v_mfma_f32_16x16x32_bf16 v[128:131], v[52:55], v[124:127], v[128:131]
    s_waitcnt lgkmcnt(1)
    s_add_u32 m0, s29, 0
    s_add_u32 s32, s45, 0
    buffer_load_dwordx4 v15, s[12:15], s32 offen  lds
    v_mfma_f32_16x16x32_bf16 v[132:135], v[56:59], v[124:127], v[132:135]
    v_mfma_f32_16x16x32_bf16 v[136:139], v[60:63], v[124:127], v[136:139]
    buffer_load_dwordx4 v16, s[12:15], s32 offen offset:1024  lds
    v_mfma_f32_16x16x32_bf16 v[140:143], v[64:67], v[124:127], v[140:143]
    v_mfma_f32_16x16x32_bf16 v[144:147], v[52:55], v[84:87], v[144:147]
    buffer_load_dwordx4 v17, s[12:15], s32 offen offset:2048  lds
    v_mfma_f32_16x16x32_bf16 v[148:151], v[56:59], v[84:87], v[148:151]
    v_mfma_f32_16x16x32_bf16 v[152:155], v[60:63], v[84:87], v[152:155]
    buffer_load_dwordx4 v18, s[12:15], s32 offen offset:3072  lds
    v_mfma_f32_16x16x32_bf16 v[156:159], v[64:67], v[84:87], v[156:159]
    v_mfma_f32_16x16x32_bf16 v[160:163], v[52:55], v[88:91], v[160:163]
    s_waitcnt vmcnt(16)
    ds_read_b64_tr_b16 v[68:69], v11 offset:4096
    v_mfma_f32_16x16x32_bf16 v[164:167], v[56:59], v[88:91], v[164:167]
    v_mfma_f32_16x16x32_bf16 v[168:171], v[60:63], v[88:91], v[168:171]
    ds_read_b64_tr_b16 v[70:71], v11 offset:4608
    v_mfma_f32_16x16x32_bf16 v[172:175], v[64:67], v[88:91], v[172:175]
    v_mfma_f32_16x16x32_bf16 v[176:179], v[52:55], v[92:95], v[176:179]
    ds_read_b64_tr_b16 v[72:73], v12 offset:4096
    v_mfma_f32_16x16x32_bf16 v[180:183], v[56:59], v[92:95], v[180:183]
    v_mfma_f32_16x16x32_bf16 v[184:187], v[60:63], v[92:95], v[184:187]
    ds_read_b64_tr_b16 v[74:75], v12 offset:4608
    v_mfma_f32_16x16x32_bf16 v[188:191], v[64:67], v[92:95], v[188:191]
    v_mfma_f32_16x16x32_bf16 v[192:195], v[52:55], v[96:99], v[192:195]
    ds_read_b64_tr_b16 v[76:77], v13 offset:4096
    v_mfma_f32_16x16x32_bf16 v[196:199], v[56:59], v[96:99], v[196:199]
    v_mfma_f32_16x16x32_bf16 v[200:203], v[60:63], v[96:99], v[200:203]
    ds_read_b64_tr_b16 v[78:79], v13 offset:4608
    v_mfma_f32_16x16x32_bf16 v[204:207], v[64:67], v[96:99], v[204:207]
    v_mfma_f32_16x16x32_bf16 v[208:211], v[52:55], v[100:103], v[208:211]
    ds_read_b64_tr_b16 v[80:81], v14 offset:4096
    v_mfma_f32_16x16x32_bf16 v[212:215], v[56:59], v[100:103], v[212:215]
    v_mfma_f32_16x16x32_bf16 v[216:219], v[60:63], v[100:103], v[216:219]
    ds_read_b64_tr_b16 v[82:83], v14 offset:4608
    v_mfma_f32_16x16x32_bf16 v[220:223], v[64:67], v[100:103], v[220:223]
    v_mfma_f32_16x16x32_bf16 v[224:227], v[52:55], v[104:107], v[224:227]
    v_mfma_f32_16x16x32_bf16 v[228:231], v[56:59], v[104:107], v[228:231]
    v_mfma_f32_16x16x32_bf16 v[232:235], v[60:63], v[104:107], v[232:235]
    ds_read_b128 v[120:123], v10 offset:18432
    v_mfma_f32_16x16x32_bf16 v[236:239], v[64:67], v[104:107], v[236:239]
    v_mfma_f32_16x16x32_bf16 v[240:243], v[52:55], v[108:111], v[240:243]
    v_mfma_f32_16x16x32_bf16 v[244:247], v[56:59], v[108:111], v[244:247]
    v_mfma_f32_16x16x32_bf16 v[248:251], v[60:63], v[108:111], v[248:251]
    v_mfma_f32_16x16x32_bf16 v[252:255], v[64:67], v[108:111], v[252:255]
    s_waitcnt lgkmcnt(7)
    v_mfma_f32_16x16x32_bf16 v[128:131], v[68:71], v[84:87], v[128:131]
    s_waitcnt lgkmcnt(1)
    s_add_u32 m0, s29, 4096
    s_add_u32 s32, s45, 1048576
    buffer_load_dwordx4 v15, s[12:15], s32 offen  lds
    v_mfma_f32_16x16x32_bf16 v[132:135], v[72:75], v[84:87], v[132:135]
    v_mfma_f32_16x16x32_bf16 v[136:139], v[76:79], v[84:87], v[136:139]
    buffer_load_dwordx4 v16, s[12:15], s32 offen offset:1024  lds
    v_mfma_f32_16x16x32_bf16 v[140:143], v[80:83], v[84:87], v[140:143]
    v_mfma_f32_16x16x32_bf16 v[144:147], v[68:71], v[88:91], v[144:147]
    buffer_load_dwordx4 v17, s[12:15], s32 offen offset:2048  lds
    v_mfma_f32_16x16x32_bf16 v[148:151], v[72:75], v[88:91], v[148:151]
    v_mfma_f32_16x16x32_bf16 v[152:155], v[76:79], v[88:91], v[152:155]
    buffer_load_dwordx4 v18, s[12:15], s32 offen offset:3072  lds
    v_mfma_f32_16x16x32_bf16 v[156:159], v[80:83], v[88:91], v[156:159]
    v_mfma_f32_16x16x32_bf16 v[160:163], v[68:71], v[92:95], v[160:163]
    s_waitcnt vmcnt(16)
    ds_read_b64_tr_b16 v[36:37], v11 offset:8192
    v_mfma_f32_16x16x32_bf16 v[164:167], v[72:75], v[92:95], v[164:167]
    v_mfma_f32_16x16x32_bf16 v[168:171], v[76:79], v[92:95], v[168:171]
    ds_read_b64_tr_b16 v[38:39], v11 offset:8704
    v_mfma_f32_16x16x32_bf16 v[172:175], v[80:83], v[92:95], v[172:175]
    v_mfma_f32_16x16x32_bf16 v[176:179], v[68:71], v[96:99], v[176:179]
    ds_read_b64_tr_b16 v[40:41], v12 offset:8192
    v_mfma_f32_16x16x32_bf16 v[180:183], v[72:75], v[96:99], v[180:183]
    v_mfma_f32_16x16x32_bf16 v[184:187], v[76:79], v[96:99], v[184:187]
    ds_read_b64_tr_b16 v[42:43], v12 offset:8704
    v_mfma_f32_16x16x32_bf16 v[188:191], v[80:83], v[96:99], v[188:191]
    v_mfma_f32_16x16x32_bf16 v[192:195], v[68:71], v[100:103], v[192:195]
    ds_read_b64_tr_b16 v[44:45], v13 offset:8192
    v_mfma_f32_16x16x32_bf16 v[196:199], v[72:75], v[100:103], v[196:199]
    v_mfma_f32_16x16x32_bf16 v[200:203], v[76:79], v[100:103], v[200:203]
    ds_read_b64_tr_b16 v[46:47], v13 offset:8704
    v_mfma_f32_16x16x32_bf16 v[204:207], v[80:83], v[100:103], v[204:207]
    v_mfma_f32_16x16x32_bf16 v[208:211], v[68:71], v[104:107], v[208:211]
    ds_read_b64_tr_b16 v[48:49], v14 offset:8192
    v_mfma_f32_16x16x32_bf16 v[212:215], v[72:75], v[104:107], v[212:215]
    v_mfma_f32_16x16x32_bf16 v[216:219], v[76:79], v[104:107], v[216:219]
    ds_read_b64_tr_b16 v[50:51], v14 offset:8704
    v_mfma_f32_16x16x32_bf16 v[220:223], v[80:83], v[104:107], v[220:223]
    v_mfma_f32_16x16x32_bf16 v[224:227], v[68:71], v[108:111], v[224:227]
    v_mfma_f32_16x16x32_bf16 v[228:231], v[72:75], v[108:111], v[228:231]
    v_mfma_f32_16x16x32_bf16 v[232:235], v[76:79], v[108:111], v[232:235]
    ds_read_b128 v[124:127], v10 offset:23040
    v_mfma_f32_16x16x32_bf16 v[236:239], v[80:83], v[108:111], v[236:239]
    v_mfma_f32_16x16x32_bf16 v[240:243], v[68:71], v[112:115], v[240:243]
    v_mfma_f32_16x16x32_bf16 v[244:247], v[72:75], v[112:115], v[244:247]
    v_mfma_f32_16x16x32_bf16 v[248:251], v[76:79], v[112:115], v[248:251]
    v_mfma_f32_16x16x32_bf16 v[252:255], v[80:83], v[112:115], v[252:255]
    s_waitcnt lgkmcnt(7)
    v_mfma_f32_16x16x32_bf16 v[128:131], v[36:39], v[88:91], v[128:131]
    s_waitcnt lgkmcnt(1)
    s_add_u32 m0, s29, 8192
    s_add_u32 s32, s45, 2097152
    buffer_load_dwordx4 v15, s[12:15], s32 offen  lds
    v_mfma_f32_16x16x32_bf16 v[132:135], v[40:43], v[88:91], v[132:135]
    v_mfma_f32_16x16x32_bf16 v[136:139], v[44:47], v[88:91], v[136:139]
    buffer_load_dwordx4 v16, s[12:15], s32 offen offset:1024  lds
    v_mfma_f32_16x16x32_bf16 v[140:143], v[48:51], v[88:91], v[140:143]
    v_mfma_f32_16x16x32_bf16 v[144:147], v[36:39], v[92:95], v[144:147]
    buffer_load_dwordx4 v17, s[12:15], s32 offen offset:2048  lds
    v_mfma_f32_16x16x32_bf16 v[148:151], v[40:43], v[92:95], v[148:151]
    v_mfma_f32_16x16x32_bf16 v[152:155], v[44:47], v[92:95], v[152:155]
    buffer_load_dwordx4 v18, s[12:15], s32 offen offset:3072  lds
    v_mfma_f32_16x16x32_bf16 v[156:159], v[48:51], v[92:95], v[156:159]
    v_mfma_f32_16x16x32_bf16 v[160:163], v[36:39], v[96:99], v[160:163]
    s_waitcnt vmcnt(16)
    ds_read_b64_tr_b16 v[52:53], v11 offset:12288
    v_mfma_f32_16x16x32_bf16 v[164:167], v[40:43], v[96:99], v[164:167]
    v_mfma_f32_16x16x32_bf16 v[168:171], v[44:47], v[96:99], v[168:171]
    ds_read_b64_tr_b16 v[54:55], v11 offset:12800
    v_mfma_f32_16x16x32_bf16 v[172:175], v[48:51], v[96:99], v[172:175]
    v_mfma_f32_16x16x32_bf16 v[176:179], v[36:39], v[100:103], v[176:179]
    ds_read_b64_tr_b16 v[56:57], v12 offset:12288
    v_mfma_f32_16x16x32_bf16 v[180:183], v[40:43], v[100:103], v[180:183]
    v_mfma_f32_16x16x32_bf16 v[184:187], v[44:47], v[100:103], v[184:187]
    ds_read_b64_tr_b16 v[58:59], v12 offset:12800
    v_mfma_f32_16x16x32_bf16 v[188:191], v[48:51], v[100:103], v[188:191]
    v_mfma_f32_16x16x32_bf16 v[192:195], v[36:39], v[104:107], v[192:195]
    ds_read_b64_tr_b16 v[60:61], v13 offset:12288
    v_mfma_f32_16x16x32_bf16 v[196:199], v[40:43], v[104:107], v[196:199]
    v_mfma_f32_16x16x32_bf16 v[200:203], v[44:47], v[104:107], v[200:203]
    ds_read_b64_tr_b16 v[62:63], v13 offset:12800
    v_mfma_f32_16x16x32_bf16 v[204:207], v[48:51], v[104:107], v[204:207]
    v_mfma_f32_16x16x32_bf16 v[208:211], v[36:39], v[108:111], v[208:211]
    ds_read_b64_tr_b16 v[64:65], v14 offset:12288
    s_waitcnt lgkmcnt(7)
    s_barrier
    v_mfma_f32_16x16x32_bf16 v[212:215], v[40:43], v[108:111], v[212:215]
    v_mfma_f32_16x16x32_bf16 v[216:219], v[44:47], v[108:111], v[216:219]
    ds_read_b64_tr_b16 v[66:67], v14 offset:12800
    ds_read_b128 v[84:87], v28 offset:0
    v_mfma_f32_16x16x32_bf16 v[220:223], v[48:51], v[108:111], v[220:223]
    v_mfma_f32_16x16x32_bf16 v[224:227], v[36:39], v[112:115], v[224:227]
    v_mfma_f32_16x16x32_bf16 v[228:231], v[40:43], v[112:115], v[228:231]
    v_mfma_f32_16x16x32_bf16 v[232:235], v[44:47], v[112:115], v[232:235]
    v_mfma_f32_16x16x32_bf16 v[236:239], v[48:51], v[112:115], v[236:239]
    v_mfma_f32_16x16x32_bf16 v[240:243], v[36:39], v[116:119], v[240:243]
    v_mfma_f32_16x16x32_bf16 v[244:247], v[40:43], v[116:119], v[244:247]
    v_mfma_f32_16x16x32_bf16 v[248:251], v[44:47], v[116:119], v[248:251]
    v_mfma_f32_16x16x32_bf16 v[252:255], v[48:51], v[116:119], v[252:255]
    s_waitcnt lgkmcnt(7)
    v_mfma_f32_16x16x32_bf16 v[128:131], v[52:55], v[92:95], v[128:131]
    s_waitcnt lgkmcnt(1)
    s_add_u32 m0, s29, 12288
    s_add_u32 s32, s45, 3145728
    buffer_load_dwordx4 v15, s[12:15], s32 offen  lds
    v_mfma_f32_16x16x32_bf16 v[132:135], v[56:59], v[92:95], v[132:135]
    v_mfma_f32_16x16x32_bf16 v[136:139], v[60:63], v[92:95], v[136:139]
    buffer_load_dwordx4 v16, s[12:15], s32 offen offset:1024  lds
    v_mfma_f32_16x16x32_bf16 v[140:143], v[64:67], v[92:95], v[140:143]
    v_mfma_f32_16x16x32_bf16 v[144:147], v[52:55], v[96:99], v[144:147]
    buffer_load_dwordx4 v17, s[12:15], s32 offen offset:2048  lds
    v_mfma_f32_16x16x32_bf16 v[148:151], v[56:59], v[96:99], v[148:151]
    ds_read_b128 v[88:91], v28 offset:4608
    v_mfma_f32_16x16x32_bf16 v[152:155], v[60:63], v[96:99], v[152:155]
    buffer_load_dwordx4 v18, s[12:15], s32 offen offset:3072  lds
    v_mfma_f32_16x16x32_bf16 v[156:159], v[64:67], v[96:99], v[156:159]
    v_mfma_f32_16x16x32_bf16 v[160:163], v[52:55], v[100:103], v[160:163]
    s_waitcnt vmcnt(16)
    ds_read_b64_tr_b16 v[68:69], v11 offset:16384
    v_mfma_f32_16x16x32_bf16 v[164:167], v[56:59], v[100:103], v[164:167]
    v_mfma_f32_16x16x32_bf16 v[168:171], v[60:63], v[100:103], v[168:171]
    ds_read_b64_tr_b16 v[70:71], v11 offset:16896
    v_mfma_f32_16x16x32_bf16 v[172:175], v[64:67], v[100:103], v[172:175]
    v_mfma_f32_16x16x32_bf16 v[176:179], v[52:55], v[104:107], v[176:179]
    ds_read_b64_tr_b16 v[72:73], v12 offset:16384
    v_mfma_f32_16x16x32_bf16 v[180:183], v[56:59], v[104:107], v[180:183]
    v_mfma_f32_16x16x32_bf16 v[184:187], v[60:63], v[104:107], v[184:187]
    ds_read_b64_tr_b16 v[74:75], v12 offset:16896
    v_mfma_f32_16x16x32_bf16 v[188:191], v[64:67], v[104:107], v[188:191]
    v_mfma_f32_16x16x32_bf16 v[192:195], v[52:55], v[108:111], v[192:195]
    ds_read_b64_tr_b16 v[76:77], v13 offset:16384
    v_mfma_f32_16x16x32_bf16 v[196:199], v[56:59], v[108:111], v[196:199]
    v_mfma_f32_16x16x32_bf16 v[200:203], v[60:63], v[108:111], v[200:203]
    ds_read_b64_tr_b16 v[78:79], v13 offset:16896
    v_mfma_f32_16x16x32_bf16 v[204:207], v[64:67], v[108:111], v[204:207]
    v_mfma_f32_16x16x32_bf16 v[208:211], v[52:55], v[112:115], v[208:211]
    ds_read_b64_tr_b16 v[80:81], v14 offset:16384
    v_mfma_f32_16x16x32_bf16 v[212:215], v[56:59], v[112:115], v[212:215]
    v_mfma_f32_16x16x32_bf16 v[216:219], v[60:63], v[112:115], v[216:219]
    ds_read_b64_tr_b16 v[82:83], v14 offset:16896
    v_mfma_f32_16x16x32_bf16 v[220:223], v[64:67], v[112:115], v[220:223]
    v_mfma_f32_16x16x32_bf16 v[224:227], v[52:55], v[116:119], v[224:227]
    ds_read_b128 v[92:95], v28 offset:9216
    v_mfma_f32_16x16x32_bf16 v[228:231], v[56:59], v[116:119], v[228:231]
    v_mfma_f32_16x16x32_bf16 v[232:235], v[60:63], v[116:119], v[232:235]
    v_mfma_f32_16x16x32_bf16 v[236:239], v[64:67], v[116:119], v[236:239]
    v_mfma_f32_16x16x32_bf16 v[240:243], v[52:55], v[120:123], v[240:243]
    v_mfma_f32_16x16x32_bf16 v[244:247], v[56:59], v[120:123], v[244:247]
    v_mfma_f32_16x16x32_bf16 v[248:251], v[60:63], v[120:123], v[248:251]
    v_mfma_f32_16x16x32_bf16 v[252:255], v[64:67], v[120:123], v[252:255]
    s_waitcnt lgkmcnt(7)
    v_mfma_f32_16x16x32_bf16 v[128:131], v[68:71], v[96:99], v[128:131]
    s_waitcnt lgkmcnt(1)
    s_add_u32 m0, s29, 16384
    s_add_u32 s32, s45, 4194304
    buffer_load_dwordx4 v15, s[12:15], s32 offen  lds
    v_mfma_f32_16x16x32_bf16 v[132:135], v[72:75], v[96:99], v[132:135]
    v_mfma_f32_16x16x32_bf16 v[136:139], v[76:79], v[96:99], v[136:139]
    buffer_load_dwordx4 v16, s[12:15], s32 offen offset:1024  lds
    v_mfma_f32_16x16x32_bf16 v[140:143], v[80:83], v[96:99], v[140:143]
    ds_read_b128 v[96:99], v28 offset:13824
    v_mfma_f32_16x16x32_bf16 v[144:147], v[68:71], v[100:103], v[144:147]
    buffer_load_dwordx4 v17, s[12:15], s32 offen offset:2048  lds
    v_mfma_f32_16x16x32_bf16 v[148:151], v[72:75], v[100:103], v[148:151]
    v_mfma_f32_16x16x32_bf16 v[152:155], v[76:79], v[100:103], v[152:155]
    buffer_load_dwordx4 v18, s[12:15], s32 offen offset:3072  lds
    v_mfma_f32_16x16x32_bf16 v[156:159], v[80:83], v[100:103], v[156:159]
    ds_read_b128 v[100:103], v28 offset:18432
    v_mfma_f32_16x16x32_bf16 v[160:163], v[68:71], v[104:107], v[160:163]
    s_waitcnt vmcnt(16)
    ds_read_b64_tr_b16 v[36:37], v11 offset:0
    v_mfma_f32_16x16x32_bf16 v[164:167], v[72:75], v[104:107], v[164:167]
    v_mfma_f32_16x16x32_bf16 v[168:171], v[76:79], v[104:107], v[168:171]
    ds_read_b64_tr_b16 v[38:39], v11 offset:512
    v_mfma_f32_16x16x32_bf16 v[172:175], v[80:83], v[104:107], v[172:175]
    ds_read_b128 v[104:107], v28 offset:23040
    v_mfma_f32_16x16x32_bf16 v[176:179], v[68:71], v[108:111], v[176:179]
    ds_read_b64_tr_b16 v[40:41], v12 offset:0
    v_mfma_f32_16x16x32_bf16 v[180:183], v[72:75], v[108:111], v[180:183]
    v_mfma_f32_16x16x32_bf16 v[184:187], v[76:79], v[108:111], v[184:187]
    ds_read_b64_tr_b16 v[42:43], v12 offset:512
    v_mfma_f32_16x16x32_bf16 v[188:191], v[80:83], v[108:111], v[188:191]
    ds_read_b128 v[108:111], v28 offset:27648
    v_mfma_f32_16x16x32_bf16 v[192:195], v[68:71], v[112:115], v[192:195]
    ds_read_b64_tr_b16 v[44:45], v13 offset:0
    v_mfma_f32_16x16x32_bf16 v[196:199], v[72:75], v[112:115], v[196:199]
    v_mfma_f32_16x16x32_bf16 v[200:203], v[76:79], v[112:115], v[200:203]
    ds_read_b64_tr_b16 v[46:47], v13 offset:512
    v_mfma_f32_16x16x32_bf16 v[204:207], v[80:83], v[112:115], v[204:207]
    ds_read_b128 v[112:115], v28 offset:32256
    v_mfma_f32_16x16x32_bf16 v[208:211], v[68:71], v[116:119], v[208:211]
    ds_read_b64_tr_b16 v[48:49], v14 offset:0
    v_mfma_f32_16x16x32_bf16 v[212:215], v[72:75], v[116:119], v[212:215]
    v_mfma_f32_16x16x32_bf16 v[216:219], v[76:79], v[116:119], v[216:219]
    ds_read_b64_tr_b16 v[50:51], v14 offset:512
    v_mfma_f32_16x16x32_bf16 v[220:223], v[80:83], v[116:119], v[220:223]
    ds_read_b128 v[116:119], v29 offset:0
    v_mfma_f32_16x16x32_bf16 v[224:227], v[68:71], v[120:123], v[224:227]
    v_mfma_f32_16x16x32_bf16 v[228:231], v[72:75], v[120:123], v[228:231]
    v_mfma_f32_16x16x32_bf16 v[232:235], v[76:79], v[120:123], v[232:235]
    v_mfma_f32_16x16x32_bf16 v[236:239], v[80:83], v[120:123], v[236:239]
    ds_read_b128 v[120:123], v29 offset:4608
    v_mfma_f32_16x16x32_bf16 v[240:243], v[68:71], v[124:127], v[240:243]
    v_mfma_f32_16x16x32_bf16 v[244:247], v[72:75], v[124:127], v[244:247]
    v_mfma_f32_16x16x32_bf16 v[248:251], v[76:79], v[124:127], v[248:251]
    v_mfma_f32_16x16x32_bf16 v[252:255], v[80:83], v[124:127], v[252:255]
    s_waitcnt lgkmcnt(11)
    v_mfma_f32_16x16x32_bf16 v[128:131], v[36:39], v[84:87], v[128:131]
    s_waitcnt lgkmcnt(2)
    s_add_u32 m0, s29, 0
    s_add_u32 s32, s45, 5242880
    buffer_load_dwordx4 v15, s[12:15], s32 offen  lds
    v_mfma_f32_16x16x32_bf16 v[132:135], v[40:43], v[84:87], v[132:135]
    v_mfma_f32_16x16x32_bf16 v[136:139], v[44:47], v[84:87], v[136:139]
    buffer_load_dwordx4 v16, s[12:15], s32 offen offset:1024  lds
    v_mfma_f32_16x16x32_bf16 v[140:143], v[48:51], v[84:87], v[140:143]
    v_mfma_f32_16x16x32_bf16 v[144:147], v[36:39], v[88:91], v[144:147]
    buffer_load_dwordx4 v17, s[12:15], s32 offen offset:2048  lds
    v_mfma_f32_16x16x32_bf16 v[148:151], v[40:43], v[88:91], v[148:151]
    v_mfma_f32_16x16x32_bf16 v[152:155], v[44:47], v[88:91], v[152:155]
    buffer_load_dwordx4 v18, s[12:15], s32 offen offset:3072  lds
    v_mfma_f32_16x16x32_bf16 v[156:159], v[48:51], v[88:91], v[156:159]
    v_mfma_f32_16x16x32_bf16 v[160:163], v[36:39], v[92:95], v[160:163]
    s_waitcnt vmcnt(16)
    ds_read_b64_tr_b16 v[52:53], v11 offset:4096
    v_mfma_f32_16x16x32_bf16 v[164:167], v[40:43], v[92:95], v[164:167]
    v_mfma_f32_16x16x32_bf16 v[168:171], v[44:47], v[92:95], v[168:171]
    ds_read_b64_tr_b16 v[54:55], v11 offset:4608
    v_mfma_f32_16x16x32_bf16 v[172:175], v[48:51], v[92:95], v[172:175]
    v_mfma_f32_16x16x32_bf16 v[176:179], v[36:39], v[96:99], v[176:179]
    ds_read_b64_tr_b16 v[56:57], v12 offset:4096
    v_mfma_f32_16x16x32_bf16 v[180:183], v[40:43], v[96:99], v[180:183]
    v_mfma_f32_16x16x32_bf16 v[184:187], v[44:47], v[96:99], v[184:187]
    ds_read_b64_tr_b16 v[58:59], v12 offset:4608
    v_mfma_f32_16x16x32_bf16 v[188:191], v[48:51], v[96:99], v[188:191]
    v_mfma_f32_16x16x32_bf16 v[192:195], v[36:39], v[100:103], v[192:195]
    ds_read_b64_tr_b16 v[60:61], v13 offset:4096
    v_mfma_f32_16x16x32_bf16 v[196:199], v[40:43], v[100:103], v[196:199]
    v_mfma_f32_16x16x32_bf16 v[200:203], v[44:47], v[100:103], v[200:203]
    ds_read_b64_tr_b16 v[62:63], v13 offset:4608
    v_mfma_f32_16x16x32_bf16 v[204:207], v[48:51], v[100:103], v[204:207]
    v_mfma_f32_16x16x32_bf16 v[208:211], v[36:39], v[104:107], v[208:211]
    ds_read_b64_tr_b16 v[64:65], v14 offset:4096
    v_mfma_f32_16x16x32_bf16 v[212:215], v[40:43], v[104:107], v[212:215]
    v_mfma_f32_16x16x32_bf16 v[216:219], v[44:47], v[104:107], v[216:219]
    ds_read_b64_tr_b16 v[66:67], v14 offset:4608
    v_mfma_f32_16x16x32_bf16 v[220:223], v[48:51], v[104:107], v[220:223]
    v_mfma_f32_16x16x32_bf16 v[224:227], v[36:39], v[108:111], v[224:227]
    v_mfma_f32_16x16x32_bf16 v[228:231], v[40:43], v[108:111], v[228:231]
    v_mfma_f32_16x16x32_bf16 v[232:235], v[44:47], v[108:111], v[232:235]
    ds_read_b128 v[124:127], v29 offset:9216
    v_mfma_f32_16x16x32_bf16 v[236:239], v[48:51], v[108:111], v[236:239]
    v_mfma_f32_16x16x32_bf16 v[240:243], v[36:39], v[112:115], v[240:243]
    v_mfma_f32_16x16x32_bf16 v[244:247], v[40:43], v[112:115], v[244:247]
    v_mfma_f32_16x16x32_bf16 v[248:251], v[44:47], v[112:115], v[248:251]
    v_mfma_f32_16x16x32_bf16 v[252:255], v[48:51], v[112:115], v[252:255]
    s_waitcnt lgkmcnt(7)
    v_mfma_f32_16x16x32_bf16 v[128:131], v[52:55], v[88:91], v[128:131]
    s_waitcnt lgkmcnt(1)
    s_add_u32 m0, s29, 4096
    s_add_u32 s32, s45, 6291456
    buffer_load_dwordx4 v15, s[12:15], s32 offen  lds
    v_mfma_f32_16x16x32_bf16 v[132:135], v[56:59], v[88:91], v[132:135]
    v_mfma_f32_16x16x32_bf16 v[136:139], v[60:63], v[88:91], v[136:139]
    buffer_load_dwordx4 v16, s[12:15], s32 offen offset:1024  lds
    v_mfma_f32_16x16x32_bf16 v[140:143], v[64:67], v[88:91], v[140:143]
    v_mfma_f32_16x16x32_bf16 v[144:147], v[52:55], v[92:95], v[144:147]
    buffer_load_dwordx4 v17, s[12:15], s32 offen offset:2048  lds
    v_mfma_f32_16x16x32_bf16 v[148:151], v[56:59], v[92:95], v[148:151]
    v_mfma_f32_16x16x32_bf16 v[152:155], v[60:63], v[92:95], v[152:155]
    buffer_load_dwordx4 v18, s[12:15], s32 offen offset:3072  lds
    v_mfma_f32_16x16x32_bf16 v[156:159], v[64:67], v[92:95], v[156:159]
    v_mfma_f32_16x16x32_bf16 v[160:163], v[52:55], v[96:99], v[160:163]
    s_waitcnt vmcnt(16)
    ds_read_b64_tr_b16 v[68:69], v11 offset:8192
    v_mfma_f32_16x16x32_bf16 v[164:167], v[56:59], v[96:99], v[164:167]
    v_mfma_f32_16x16x32_bf16 v[168:171], v[60:63], v[96:99], v[168:171]
    ds_read_b64_tr_b16 v[70:71], v11 offset:8704
    v_mfma_f32_16x16x32_bf16 v[172:175], v[64:67], v[96:99], v[172:175]
    v_mfma_f32_16x16x32_bf16 v[176:179], v[52:55], v[100:103], v[176:179]
    ds_read_b64_tr_b16 v[72:73], v12 offset:8192
    v_mfma_f32_16x16x32_bf16 v[180:183], v[56:59], v[100:103], v[180:183]
    v_mfma_f32_16x16x32_bf16 v[184:187], v[60:63], v[100:103], v[184:187]
    ds_read_b64_tr_b16 v[74:75], v12 offset:8704
    v_mfma_f32_16x16x32_bf16 v[188:191], v[64:67], v[100:103], v[188:191]
    v_mfma_f32_16x16x32_bf16 v[192:195], v[52:55], v[104:107], v[192:195]
    ds_read_b64_tr_b16 v[76:77], v13 offset:8192
    v_mfma_f32_16x16x32_bf16 v[196:199], v[56:59], v[104:107], v[196:199]
    v_mfma_f32_16x16x32_bf16 v[200:203], v[60:63], v[104:107], v[200:203]
    ds_read_b64_tr_b16 v[78:79], v13 offset:8704
    v_mfma_f32_16x16x32_bf16 v[204:207], v[64:67], v[104:107], v[204:207]
    v_mfma_f32_16x16x32_bf16 v[208:211], v[52:55], v[108:111], v[208:211]
    ds_read_b64_tr_b16 v[80:81], v14 offset:8192
    v_mfma_f32_16x16x32_bf16 v[212:215], v[56:59], v[108:111], v[212:215]
    v_mfma_f32_16x16x32_bf16 v[216:219], v[60:63], v[108:111], v[216:219]
    ds_read_b64_tr_b16 v[82:83], v14 offset:8704
    v_mfma_f32_16x16x32_bf16 v[220:223], v[64:67], v[108:111], v[220:223]
    v_mfma_f32_16x16x32_bf16 v[224:227], v[52:55], v[112:115], v[224:227]
    v_mfma_f32_16x16x32_bf16 v[228:231], v[56:59], v[112:115], v[228:231]
    v_mfma_f32_16x16x32_bf16 v[232:235], v[60:63], v[112:115], v[232:235]
    ds_read_b128 v[84:87], v29 offset:13824
    v_mfma_f32_16x16x32_bf16 v[236:239], v[64:67], v[112:115], v[236:239]
    v_mfma_f32_16x16x32_bf16 v[240:243], v[52:55], v[116:119], v[240:243]
    v_mfma_f32_16x16x32_bf16 v[244:247], v[56:59], v[116:119], v[244:247]
    v_mfma_f32_16x16x32_bf16 v[248:251], v[60:63], v[116:119], v[248:251]
    v_mfma_f32_16x16x32_bf16 v[252:255], v[64:67], v[116:119], v[252:255]
    s_waitcnt lgkmcnt(7)
    v_mfma_f32_16x16x32_bf16 v[128:131], v[68:71], v[92:95], v[128:131]
    s_waitcnt lgkmcnt(1)
    s_add_u32 m0, s29, 8192
    s_add_u32 s32, s45, 7340032
    buffer_load_dwordx4 v15, s[12:15], s32 offen  lds
    v_mfma_f32_16x16x32_bf16 v[132:135], v[72:75], v[92:95], v[132:135]
    v_mfma_f32_16x16x32_bf16 v[136:139], v[76:79], v[92:95], v[136:139]
    buffer_load_dwordx4 v16, s[12:15], s32 offen offset:1024  lds
    v_mfma_f32_16x16x32_bf16 v[140:143], v[80:83], v[92:95], v[140:143]
    v_mfma_f32_16x16x32_bf16 v[144:147], v[68:71], v[96:99], v[144:147]
    buffer_load_dwordx4 v17, s[12:15], s32 offen offset:2048  lds
    v_mfma_f32_16x16x32_bf16 v[148:151], v[72:75], v[96:99], v[148:151]
    v_mfma_f32_16x16x32_bf16 v[152:155], v[76:79], v[96:99], v[152:155]
    buffer_load_dwordx4 v18, s[12:15], s32 offen offset:3072  lds
    v_mfma_f32_16x16x32_bf16 v[156:159], v[80:83], v[96:99], v[156:159]
    v_mfma_f32_16x16x32_bf16 v[160:163], v[68:71], v[100:103], v[160:163]
    s_waitcnt vmcnt(16)
    ds_read_b64_tr_b16 v[36:37], v11 offset:12288
    v_mfma_f32_16x16x32_bf16 v[164:167], v[72:75], v[100:103], v[164:167]
    v_mfma_f32_16x16x32_bf16 v[168:171], v[76:79], v[100:103], v[168:171]
    ds_read_b64_tr_b16 v[38:39], v11 offset:12800
    v_mfma_f32_16x16x32_bf16 v[172:175], v[80:83], v[100:103], v[172:175]
    v_mfma_f32_16x16x32_bf16 v[176:179], v[68:71], v[104:107], v[176:179]
    ds_read_b64_tr_b16 v[40:41], v12 offset:12288
    v_mfma_f32_16x16x32_bf16 v[180:183], v[72:75], v[104:107], v[180:183]
    v_mfma_f32_16x16x32_bf16 v[184:187], v[76:79], v[104:107], v[184:187]
    ds_read_b64_tr_b16 v[42:43], v12 offset:12800
    v_mfma_f32_16x16x32_bf16 v[188:191], v[80:83], v[104:107], v[188:191]
    v_mfma_f32_16x16x32_bf16 v[192:195], v[68:71], v[108:111], v[192:195]
    ds_read_b64_tr_b16 v[44:45], v13 offset:12288
    v_mfma_f32_16x16x32_bf16 v[196:199], v[72:75], v[108:111], v[196:199]
    v_mfma_f32_16x16x32_bf16 v[200:203], v[76:79], v[108:111], v[200:203]
    ds_read_b64_tr_b16 v[46:47], v13 offset:12800
    v_mfma_f32_16x16x32_bf16 v[204:207], v[80:83], v[108:111], v[204:207]
    v_mfma_f32_16x16x32_bf16 v[208:211], v[68:71], v[112:115], v[208:211]
    ds_read_b64_tr_b16 v[48:49], v14 offset:12288
    v_mfma_f32_16x16x32_bf16 v[212:215], v[72:75], v[112:115], v[212:215]
    v_mfma_f32_16x16x32_bf16 v[216:219], v[76:79], v[112:115], v[216:219]
    ds_read_b64_tr_b16 v[50:51], v14 offset:12800
    v_mfma_f32_16x16x32_bf16 v[220:223], v[80:83], v[112:115], v[220:223]
    v_mfma_f32_16x16x32_bf16 v[224:227], v[68:71], v[116:119], v[224:227]
    v_mfma_f32_16x16x32_bf16 v[228:231], v[72:75], v[116:119], v[228:231]
    v_mfma_f32_16x16x32_bf16 v[232:235], v[76:79], v[116:119], v[232:235]
    ds_read_b128 v[88:91], v29 offset:18432
    v_mfma_f32_16x16x32_bf16 v[236:239], v[80:83], v[116:119], v[236:239]
    v_mfma_f32_16x16x32_bf16 v[240:243], v[68:71], v[120:123], v[240:243]
    v_mfma_f32_16x16x32_bf16 v[244:247], v[72:75], v[120:123], v[244:247]
    v_mfma_f32_16x16x32_bf16 v[248:251], v[76:79], v[120:123], v[248:251]
    v_mfma_f32_16x16x32_bf16 v[252:255], v[80:83], v[120:123], v[252:255]
    s_waitcnt lgkmcnt(7)
    v_mfma_f32_16x16x32_bf16 v[128:131], v[36:39], v[96:99], v[128:131]
    s_waitcnt lgkmcnt(1)
    s_add_u32 m0, s29, 12288
    s_add_u32 s32, s45, 8388608
    buffer_load_dwordx4 v15, s[12:15], s32 offen  lds
    v_mfma_f32_16x16x32_bf16 v[132:135], v[40:43], v[96:99], v[132:135]
    v_mfma_f32_16x16x32_bf16 v[136:139], v[44:47], v[96:99], v[136:139]
    buffer_load_dwordx4 v16, s[12:15], s32 offen offset:1024  lds
    v_mfma_f32_16x16x32_bf16 v[140:143], v[48:51], v[96:99], v[140:143]
    v_mfma_f32_16x16x32_bf16 v[144:147], v[36:39], v[100:103], v[144:147]
    buffer_load_dwordx4 v17, s[12:15], s32 offen offset:2048  lds
    v_mfma_f32_16x16x32_bf16 v[148:151], v[40:43], v[100:103], v[148:151]
    v_mfma_f32_16x16x32_bf16 v[152:155], v[44:47], v[100:103], v[152:155]
    buffer_load_dwordx4 v18, s[12:15], s32 offen offset:3072  lds
    v_mfma_f32_16x16x32_bf16 v[156:159], v[48:51], v[100:103], v[156:159]
    v_mfma_f32_16x16x32_bf16 v[160:163], v[36:39], v[104:107], v[160:163]
    s_waitcnt vmcnt(16)
    ds_read_b64_tr_b16 v[52:53], v11 offset:16384
    v_mfma_f32_16x16x32_bf16 v[164:167], v[40:43], v[104:107], v[164:167]
    v_mfma_f32_16x16x32_bf16 v[168:171], v[44:47], v[104:107], v[168:171]
    ds_read_b64_tr_b16 v[54:55], v11 offset:16896
    v_mfma_f32_16x16x32_bf16 v[172:175], v[48:51], v[104:107], v[172:175]
    v_mfma_f32_16x16x32_bf16 v[176:179], v[36:39], v[108:111], v[176:179]
    ds_read_b64_tr_b16 v[56:57], v12 offset:16384
    v_mfma_f32_16x16x32_bf16 v[180:183], v[40:43], v[108:111], v[180:183]
    v_mfma_f32_16x16x32_bf16 v[184:187], v[44:47], v[108:111], v[184:187]
    ds_read_b64_tr_b16 v[58:59], v12 offset:16896
    v_mfma_f32_16x16x32_bf16 v[188:191], v[48:51], v[108:111], v[188:191]
    v_mfma_f32_16x16x32_bf16 v[192:195], v[36:39], v[112:115], v[192:195]
    ds_read_b64_tr_b16 v[60:61], v13 offset:16384
    v_mfma_f32_16x16x32_bf16 v[196:199], v[40:43], v[112:115], v[196:199]
    v_mfma_f32_16x16x32_bf16 v[200:203], v[44:47], v[112:115], v[200:203]
    ds_read_b64_tr_b16 v[62:63], v13 offset:16896
    v_mfma_f32_16x16x32_bf16 v[204:207], v[48:51], v[112:115], v[204:207]
    v_mfma_f32_16x16x32_bf16 v[208:211], v[36:39], v[116:119], v[208:211]
    ds_read_b64_tr_b16 v[64:65], v14 offset:16384
    v_mfma_f32_16x16x32_bf16 v[212:215], v[40:43], v[116:119], v[212:215]
    v_mfma_f32_16x16x32_bf16 v[216:219], v[44:47], v[116:119], v[216:219]
    ds_read_b64_tr_b16 v[66:67], v14 offset:16896
    v_mfma_f32_16x16x32_bf16 v[220:223], v[48:51], v[116:119], v[220:223]
    v_mfma_f32_16x16x32_bf16 v[224:227], v[36:39], v[120:123], v[224:227]
    v_mfma_f32_16x16x32_bf16 v[228:231], v[40:43], v[120:123], v[228:231]
    v_mfma_f32_16x16x32_bf16 v[232:235], v[44:47], v[120:123], v[232:235]
    ds_read_b128 v[92:95], v29 offset:23040
    v_mfma_f32_16x16x32_bf16 v[236:239], v[48:51], v[120:123], v[236:239]
    v_mfma_f32_16x16x32_bf16 v[240:243], v[36:39], v[124:127], v[240:243]
    v_mfma_f32_16x16x32_bf16 v[244:247], v[40:43], v[124:127], v[244:247]
    v_mfma_f32_16x16x32_bf16 v[248:251], v[44:47], v[124:127], v[248:251]
    v_mfma_f32_16x16x32_bf16 v[252:255], v[48:51], v[124:127], v[252:255]
    s_waitcnt lgkmcnt(7)
    v_mfma_f32_16x16x32_bf16 v[128:131], v[52:55], v[100:103], v[128:131]
    s_waitcnt lgkmcnt(1)
    s_add_u32 m0, s29, 16384
    s_add_u32 s32, s45, 9437184
    buffer_load_dwordx4 v15, s[12:15], s32 offen  lds
    v_mfma_f32_16x16x32_bf16 v[132:135], v[56:59], v[100:103], v[132:135]
    v_mfma_f32_16x16x32_bf16 v[136:139], v[60:63], v[100:103], v[136:139]
    buffer_load_dwordx4 v16, s[12:15], s32 offen offset:1024  lds
    v_mfma_f32_16x16x32_bf16 v[140:143], v[64:67], v[100:103], v[140:143]
    v_mfma_f32_16x16x32_bf16 v[144:147], v[52:55], v[104:107], v[144:147]
    buffer_load_dwordx4 v17, s[12:15], s32 offen offset:2048  lds
    v_mfma_f32_16x16x32_bf16 v[148:151], v[56:59], v[104:107], v[148:151]
    v_mfma_f32_16x16x32_bf16 v[152:155], v[60:63], v[104:107], v[152:155]
    buffer_load_dwordx4 v18, s[12:15], s32 offen offset:3072  lds
    v_mfma_f32_16x16x32_bf16 v[156:159], v[64:67], v[104:107], v[156:159]
    v_mfma_f32_16x16x32_bf16 v[160:163], v[52:55], v[108:111], v[160:163]
    s_waitcnt vmcnt(16)
    ds_read_b64_tr_b16 v[68:69], v11 offset:0
    v_mfma_f32_16x16x32_bf16 v[164:167], v[56:59], v[108:111], v[164:167]
    v_mfma_f32_16x16x32_bf16 v[168:171], v[60:63], v[108:111], v[168:171]
    ds_read_b64_tr_b16 v[70:71], v11 offset:512
    v_mfma_f32_16x16x32_bf16 v[172:175], v[64:67], v[108:111], v[172:175]
    v_mfma_f32_16x16x32_bf16 v[176:179], v[52:55], v[112:115], v[176:179]
    ds_read_b64_tr_b16 v[72:73], v12 offset:0
    v_mfma_f32_16x16x32_bf16 v[180:183], v[56:59], v[112:115], v[180:183]
    v_mfma_f32_16x16x32_bf16 v[184:187], v[60:63], v[112:115], v[184:187]
    ds_read_b64_tr_b16 v[74:75], v12 offset:512
    v_mfma_f32_16x16x32_bf16 v[188:191], v[64:67], v[112:115], v[188:191]
    v_mfma_f32_16x16x32_bf16 v[192:195], v[52:55], v[116:119], v[192:195]
    ds_read_b64_tr_b16 v[76:77], v13 offset:0
    v_mfma_f32_16x16x32_bf16 v[196:199], v[56:59], v[116:119], v[196:199]
    v_mfma_f32_16x16x32_bf16 v[200:203], v[60:63], v[116:119], v[200:203]
    ds_read_b64_tr_b16 v[78:79], v13 offset:512
    v_mfma_f32_16x16x32_bf16 v[204:207], v[64:67], v[116:119], v[204:207]
    v_mfma_f32_16x16x32_bf16 v[208:211], v[52:55], v[120:123], v[208:211]
    ds_read_b64_tr_b16 v[80:81], v14 offset:0
    v_mfma_f32_16x16x32_bf16 v[212:215], v[56:59], v[120:123], v[212:215]
    v_mfma_f32_16x16x32_bf16 v[216:219], v[60:63], v[120:123], v[216:219]
    ds_read_b64_tr_b16 v[82:83], v14 offset:512
    v_mfma_f32_16x16x32_bf16 v[220:223], v[64:67], v[120:123], v[220:223]
    v_mfma_f32_16x16x32_bf16 v[224:227], v[52:55], v[124:127], v[224:227]
    v_mfma_f32_16x16x32_bf16 v[228:231], v[56:59], v[124:127], v[228:231]
    v_mfma_f32_16x16x32_bf16 v[232:235], v[60:63], v[124:127], v[232:235]
    ds_read_b128 v[96:99], v29 offset:27648
    v_mfma_f32_16x16x32_bf16 v[236:239], v[64:67], v[124:127], v[236:239]
    v_mfma_f32_16x16x32_bf16 v[240:243], v[52:55], v[84:87], v[240:243]
    v_mfma_f32_16x16x32_bf16 v[244:247], v[56:59], v[84:87], v[244:247]
    v_mfma_f32_16x16x32_bf16 v[248:251], v[60:63], v[84:87], v[248:251]
    v_mfma_f32_16x16x32_bf16 v[252:255], v[64:67], v[84:87], v[252:255]
    s_waitcnt lgkmcnt(7)
    v_mfma_f32_16x16x32_bf16 v[128:131], v[68:71], v[104:107], v[128:131]
    s_waitcnt lgkmcnt(1)
    s_add_u32 m0, s29, 0
    s_add_u32 s32, s45, 10485760
    buffer_load_dwordx4 v15, s[12:15], s32 offen  lds
    v_mfma_f32_16x16x32_bf16 v[132:135], v[72:75], v[104:107], v[132:135]
    v_mfma_f32_16x16x32_bf16 v[136:139], v[76:79], v[104:107], v[136:139]
    buffer_load_dwordx4 v16, s[12:15], s32 offen offset:1024  lds
    v_mfma_f32_16x16x32_bf16 v[140:143], v[80:83], v[104:107], v[140:143]
    v_mfma_f32_16x16x32_bf16 v[144:147], v[68:71], v[108:111], v[144:147]
    buffer_load_dwordx4 v17, s[12:15], s32 offen offset:2048  lds
    v_mfma_f32_16x16x32_bf16 v[148:151], v[72:75], v[108:111], v[148:151]
    v_mfma_f32_16x16x32_bf16 v[152:155], v[76:79], v[108:111], v[152:155]
    buffer_load_dwordx4 v18, s[12:15], s32 offen offset:3072  lds
    v_mfma_f32_16x16x32_bf16 v[156:159], v[80:83], v[108:111], v[156:159]
    v_mfma_f32_16x16x32_bf16 v[160:163], v[68:71], v[112:115], v[160:163]
    s_waitcnt vmcnt(16)
    ds_read_b64_tr_b16 v[36:37], v11 offset:4096
    v_mfma_f32_16x16x32_bf16 v[164:167], v[72:75], v[112:115], v[164:167]
    v_mfma_f32_16x16x32_bf16 v[168:171], v[76:79], v[112:115], v[168:171]
    ds_read_b64_tr_b16 v[38:39], v11 offset:4608
    v_mfma_f32_16x16x32_bf16 v[172:175], v[80:83], v[112:115], v[172:175]
    v_mfma_f32_16x16x32_bf16 v[176:179], v[68:71], v[116:119], v[176:179]
    ds_read_b64_tr_b16 v[40:41], v12 offset:4096
    v_mfma_f32_16x16x32_bf16 v[180:183], v[72:75], v[116:119], v[180:183]
    v_mfma_f32_16x16x32_bf16 v[184:187], v[76:79], v[116:119], v[184:187]
    ds_read_b64_tr_b16 v[42:43], v12 offset:4608
    v_mfma_f32_16x16x32_bf16 v[188:191], v[80:83], v[116:119], v[188:191]
    v_mfma_f32_16x16x32_bf16 v[192:195], v[68:71], v[120:123], v[192:195]
    ds_read_b64_tr_b16 v[44:45], v13 offset:4096
    v_mfma_f32_16x16x32_bf16 v[196:199], v[72:75], v[120:123], v[196:199]
    v_mfma_f32_16x16x32_bf16 v[200:203], v[76:79], v[120:123], v[200:203]
    ds_read_b64_tr_b16 v[46:47], v13 offset:4608
    v_mfma_f32_16x16x32_bf16 v[204:207], v[80:83], v[120:123], v[204:207]
    v_mfma_f32_16x16x32_bf16 v[208:211], v[68:71], v[124:127], v[208:211]
    ds_read_b64_tr_b16 v[48:49], v14 offset:4096
    v_mfma_f32_16x16x32_bf16 v[212:215], v[72:75], v[124:127], v[212:215]
    v_mfma_f32_16x16x32_bf16 v[216:219], v[76:79], v[124:127], v[216:219]
    ds_read_b64_tr_b16 v[50:51], v14 offset:4608
    v_mfma_f32_16x16x32_bf16 v[220:223], v[80:83], v[124:127], v[220:223]
    v_mfma_f32_16x16x32_bf16 v[224:227], v[68:71], v[84:87], v[224:227]
    v_mfma_f32_16x16x32_bf16 v[228:231], v[72:75], v[84:87], v[228:231]
    v_mfma_f32_16x16x32_bf16 v[232:235], v[76:79], v[84:87], v[232:235]
    ds_read_b128 v[100:103], v29 offset:32256
    v_mfma_f32_16x16x32_bf16 v[236:239], v[80:83], v[84:87], v[236:239]
    v_mfma_f32_16x16x32_bf16 v[240:243], v[68:71], v[88:91], v[240:243]
    v_mfma_f32_16x16x32_bf16 v[244:247], v[72:75], v[88:91], v[244:247]
    v_mfma_f32_16x16x32_bf16 v[248:251], v[76:79], v[88:91], v[248:251]
    v_mfma_f32_16x16x32_bf16 v[252:255], v[80:83], v[88:91], v[252:255]
    s_waitcnt lgkmcnt(7)
    v_mfma_f32_16x16x32_bf16 v[128:131], v[36:39], v[108:111], v[128:131]
    s_waitcnt lgkmcnt(1)
    s_add_u32 m0, s29, 4096
    s_add_u32 s32, s45, 11534336
    buffer_load_dwordx4 v15, s[12:15], s32 offen  lds
    v_mfma_f32_16x16x32_bf16 v[132:135], v[40:43], v[108:111], v[132:135]
    v_mfma_f32_16x16x32_bf16 v[136:139], v[44:47], v[108:111], v[136:139]
    buffer_load_dwordx4 v16, s[12:15], s32 offen offset:1024  lds
    v_mfma_f32_16x16x32_bf16 v[140:143], v[48:51], v[108:111], v[140:143]
    v_mfma_f32_16x16x32_bf16 v[144:147], v[36:39], v[112:115], v[144:147]
    buffer_load_dwordx4 v17, s[12:15], s32 offen offset:2048  lds
    v_mfma_f32_16x16x32_bf16 v[148:151], v[40:43], v[112:115], v[148:151]
    v_mfma_f32_16x16x32_bf16 v[152:155], v[44:47], v[112:115], v[152:155]
    buffer_load_dwordx4 v18, s[12:15], s32 offen offset:3072  lds
    v_mfma_f32_16x16x32_bf16 v[156:159], v[48:51], v[112:115], v[156:159]
    v_mfma_f32_16x16x32_bf16 v[160:163], v[36:39], v[116:119], v[160:163]
    s_waitcnt vmcnt(16)
    ds_read_b64_tr_b16 v[52:53], v11 offset:8192
    v_mfma_f32_16x16x32_bf16 v[164:167], v[40:43], v[116:119], v[164:167]
    v_mfma_f32_16x16x32_bf16 v[168:171], v[44:47], v[116:119], v[168:171]
    ds_read_b64_tr_b16 v[54:55], v11 offset:8704
    v_mfma_f32_16x16x32_bf16 v[172:175], v[48:51], v[116:119], v[172:175]
    v_mfma_f32_16x16x32_bf16 v[176:179], v[36:39], v[120:123], v[176:179]
    ds_read_b64_tr_b16 v[56:57], v12 offset:8192
    v_mfma_f32_16x16x32_bf16 v[180:183], v[40:43], v[120:123], v[180:183]
    v_mfma_f32_16x16x32_bf16 v[184:187], v[44:47], v[120:123], v[184:187]
    ds_read_b64_tr_b16 v[58:59], v12 offset:8704
    v_mfma_f32_16x16x32_bf16 v[188:191], v[48:51], v[120:123], v[188:191]
    v_mfma_f32_16x16x32_bf16 v[192:195], v[36:39], v[124:127], v[192:195]
    ds_read_b64_tr_b16 v[60:61], v13 offset:8192
    v_mfma_f32_16x16x32_bf16 v[196:199], v[40:43], v[124:127], v[196:199]
    v_mfma_f32_16x16x32_bf16 v[200:203], v[44:47], v[124:127], v[200:203]
    ds_read_b64_tr_b16 v[62:63], v13 offset:8704
    v_mfma_f32_16x16x32_bf16 v[204:207], v[48:51], v[124:127], v[204:207]
    v_mfma_f32_16x16x32_bf16 v[208:211], v[36:39], v[84:87], v[208:211]
    ds_read_b64_tr_b16 v[64:65], v14 offset:8192
    v_mfma_f32_16x16x32_bf16 v[212:215], v[40:43], v[84:87], v[212:215]
    v_mfma_f32_16x16x32_bf16 v[216:219], v[44:47], v[84:87], v[216:219]
    ds_read_b64_tr_b16 v[66:67], v14 offset:8704
    v_mfma_f32_16x16x32_bf16 v[220:223], v[48:51], v[84:87], v[220:223]
    v_mfma_f32_16x16x32_bf16 v[224:227], v[36:39], v[88:91], v[224:227]
    v_mfma_f32_16x16x32_bf16 v[228:231], v[40:43], v[88:91], v[228:231]
    v_mfma_f32_16x16x32_bf16 v[232:235], v[44:47], v[88:91], v[232:235]
    ds_read_b128 v[104:107], v30 offset:0
    v_mfma_f32_16x16x32_bf16 v[236:239], v[48:51], v[88:91], v[236:239]
    v_mfma_f32_16x16x32_bf16 v[240:243], v[36:39], v[92:95], v[240:243]
    v_mfma_f32_16x16x32_bf16 v[244:247], v[40:43], v[92:95], v[244:247]
    v_mfma_f32_16x16x32_bf16 v[248:251], v[44:47], v[92:95], v[248:251]
    v_mfma_f32_16x16x32_bf16 v[252:255], v[48:51], v[92:95], v[252:255]
    s_waitcnt lgkmcnt(7)
    v_mfma_f32_16x16x32_bf16 v[128:131], v[52:55], v[112:115], v[128:131]
    s_waitcnt lgkmcnt(1)
    s_add_u32 m0, s29, 8192
    s_add_u32 s32, s45, 12582912
    buffer_load_dwordx4 v15, s[12:15], s32 offen  lds
    v_mfma_f32_16x16x32_bf16 v[132:135], v[56:59], v[112:115], v[132:135]
    v_mfma_f32_16x16x32_bf16 v[136:139], v[60:63], v[112:115], v[136:139]
    buffer_load_dwordx4 v16, s[12:15], s32 offen offset:1024  lds
    v_mfma_f32_16x16x32_bf16 v[140:143], v[64:67], v[112:115], v[140:143]
    v_mfma_f32_16x16x32_bf16 v[144:147], v[52:55], v[116:119], v[144:147]
    buffer_load_dwordx4 v17, s[12:15], s32 offen offset:2048  lds
    v_mfma_f32_16x16x32_bf16 v[148:151], v[56:59], v[116:119], v[148:151]
    v_mfma_f32_16x16x32_bf16 v[152:155], v[60:63], v[116:119], v[152:155]
    buffer_load_dwordx4 v18, s[12:15], s32 offen offset:3072  lds
    v_mfma_f32_16x16x32_bf16 v[156:159], v[64:67], v[116:119], v[156:159]
    v_mfma_f32_16x16x32_bf16 v[160:163], v[52:55], v[120:123], v[160:163]
    s_waitcnt vmcnt(16)
    ds_read_b64_tr_b16 v[68:69], v11 offset:12288
    v_mfma_f32_16x16x32_bf16 v[164:167], v[56:59], v[120:123], v[164:167]
    v_mfma_f32_16x16x32_bf16 v[168:171], v[60:63], v[120:123], v[168:171]
    ds_read_b64_tr_b16 v[70:71], v11 offset:12800
    v_mfma_f32_16x16x32_bf16 v[172:175], v[64:67], v[120:123], v[172:175]
    v_mfma_f32_16x16x32_bf16 v[176:179], v[52:55], v[124:127], v[176:179]
    ds_read_b64_tr_b16 v[72:73], v12 offset:12288
    v_mfma_f32_16x16x32_bf16 v[180:183], v[56:59], v[124:127], v[180:183]
    v_mfma_f32_16x16x32_bf16 v[184:187], v[60:63], v[124:127], v[184:187]
    ds_read_b64_tr_b16 v[74:75], v12 offset:12800
    v_mfma_f32_16x16x32_bf16 v[188:191], v[64:67], v[124:127], v[188:191]
    v_mfma_f32_16x16x32_bf16 v[192:195], v[52:55], v[84:87], v[192:195]
    ds_read_b64_tr_b16 v[76:77], v13 offset:12288
    v_mfma_f32_16x16x32_bf16 v[196:199], v[56:59], v[84:87], v[196:199]
    v_mfma_f32_16x16x32_bf16 v[200:203], v[60:63], v[84:87], v[200:203]
    ds_read_b64_tr_b16 v[78:79], v13 offset:12800
    v_mfma_f32_16x16x32_bf16 v[204:207], v[64:67], v[84:87], v[204:207]
    v_mfma_f32_16x16x32_bf16 v[208:211], v[52:55], v[88:91], v[208:211]
    ds_read_b64_tr_b16 v[80:81], v14 offset:12288
    v_mfma_f32_16x16x32_bf16 v[212:215], v[56:59], v[88:91], v[212:215]
    v_mfma_f32_16x16x32_bf16 v[216:219], v[60:63], v[88:91], v[216:219]
    ds_read_b64_tr_b16 v[82:83], v14 offset:12800
    v_mfma_f32_16x16x32_bf16 v[220:223], v[64:67], v[88:91], v[220:223]
    v_mfma_f32_16x16x32_bf16 v[224:227], v[52:55], v[92:95], v[224:227]
    v_mfma_f32_16x16x32_bf16 v[228:231], v[56:59], v[92:95], v[228:231]
    v_mfma_f32_16x16x32_bf16 v[232:235], v[60:63], v[92:95], v[232:235]
    ds_read_b128 v[108:111], v30 offset:4608
    v_mfma_f32_16x16x32_bf16 v[236:239], v[64:67], v[92:95], v[236:239]
    v_mfma_f32_16x16x32_bf16 v[240:243], v[52:55], v[96:99], v[240:243]
    v_mfma_f32_16x16x32_bf16 v[244:247], v[56:59], v[96:99], v[244:247]
    v_mfma_f32_16x16x32_bf16 v[248:251], v[60:63], v[96:99], v[248:251]
    v_mfma_f32_16x16x32_bf16 v[252:255], v[64:67], v[96:99], v[252:255]
    s_waitcnt lgkmcnt(7)
    v_mfma_f32_16x16x32_bf16 v[128:131], v[68:71], v[116:119], v[128:131]
    s_waitcnt lgkmcnt(1)
    s_add_u32 m0, s29, 12288
    s_add_u32 s32, s45, 13631488
    buffer_load_dwordx4 v15, s[12:15], s32 offen  lds
    v_mfma_f32_16x16x32_bf16 v[132:135], v[72:75], v[116:119], v[132:135]
    v_mfma_f32_16x16x32_bf16 v[136:139], v[76:79], v[116:119], v[136:139]
    buffer_load_dwordx4 v16, s[12:15], s32 offen offset:1024  lds
    v_mfma_f32_16x16x32_bf16 v[140:143], v[80:83], v[116:119], v[140:143]
    v_mfma_f32_16x16x32_bf16 v[144:147], v[68:71], v[120:123], v[144:147]
    buffer_load_dwordx4 v17, s[12:15], s32 offen offset:2048  lds
    v_mfma_f32_16x16x32_bf16 v[148:151], v[72:75], v[120:123], v[148:151]
    v_mfma_f32_16x16x32_bf16 v[152:155], v[76:79], v[120:123], v[152:155]
    buffer_load_dwordx4 v18, s[12:15], s32 offen offset:3072  lds
    v_mfma_f32_16x16x32_bf16 v[156:159], v[80:83], v[120:123], v[156:159]
    v_mfma_f32_16x16x32_bf16 v[160:163], v[68:71], v[124:127], v[160:163]
    s_waitcnt vmcnt(16)
    ds_read_b64_tr_b16 v[36:37], v11 offset:16384
    v_mfma_f32_16x16x32_bf16 v[164:167], v[72:75], v[124:127], v[164:167]
    v_mfma_f32_16x16x32_bf16 v[168:171], v[76:79], v[124:127], v[168:171]
    ds_read_b64_tr_b16 v[38:39], v11 offset:16896
    v_mfma_f32_16x16x32_bf16 v[172:175], v[80:83], v[124:127], v[172:175]
    v_mfma_f32_16x16x32_bf16 v[176:179], v[68:71], v[84:87], v[176:179]
    ds_read_b64_tr_b16 v[40:41], v12 offset:16384
    v_mfma_f32_16x16x32_bf16 v[180:183], v[72:75], v[84:87], v[180:183]
    v_mfma_f32_16x16x32_bf16 v[184:187], v[76:79], v[84:87], v[184:187]
    ds_read_b64_tr_b16 v[42:43], v12 offset:16896
    v_mfma_f32_16x16x32_bf16 v[188:191], v[80:83], v[84:87], v[188:191]
    v_mfma_f32_16x16x32_bf16 v[192:195], v[68:71], v[88:91], v[192:195]
    ds_read_b64_tr_b16 v[44:45], v13 offset:16384
    v_mfma_f32_16x16x32_bf16 v[196:199], v[72:75], v[88:91], v[196:199]
    v_mfma_f32_16x16x32_bf16 v[200:203], v[76:79], v[88:91], v[200:203]
    ds_read_b64_tr_b16 v[46:47], v13 offset:16896
    v_mfma_f32_16x16x32_bf16 v[204:207], v[80:83], v[88:91], v[204:207]
    v_mfma_f32_16x16x32_bf16 v[208:211], v[68:71], v[92:95], v[208:211]
    ds_read_b64_tr_b16 v[48:49], v14 offset:16384
    v_mfma_f32_16x16x32_bf16 v[212:215], v[72:75], v[92:95], v[212:215]
    v_mfma_f32_16x16x32_bf16 v[216:219], v[76:79], v[92:95], v[216:219]
    ds_read_b64_tr_b16 v[50:51], v14 offset:16896
    v_mfma_f32_16x16x32_bf16 v[220:223], v[80:83], v[92:95], v[220:223]
    v_mfma_f32_16x16x32_bf16 v[224:227], v[68:71], v[96:99], v[224:227]
    v_mfma_f32_16x16x32_bf16 v[228:231], v[72:75], v[96:99], v[228:231]
    v_mfma_f32_16x16x32_bf16 v[232:235], v[76:79], v[96:99], v[232:235]
    ds_read_b128 v[112:115], v30 offset:9216
    v_mfma_f32_16x16x32_bf16 v[236:239], v[80:83], v[96:99], v[236:239]
    v_mfma_f32_16x16x32_bf16 v[240:243], v[68:71], v[100:103], v[240:243]
    v_mfma_f32_16x16x32_bf16 v[244:247], v[72:75], v[100:103], v[244:247]
    v_mfma_f32_16x16x32_bf16 v[248:251], v[76:79], v[100:103], v[248:251]
    v_mfma_f32_16x16x32_bf16 v[252:255], v[80:83], v[100:103], v[252:255]
    s_waitcnt lgkmcnt(7)
    v_mfma_f32_16x16x32_bf16 v[128:131], v[36:39], v[120:123], v[128:131]
    s_waitcnt lgkmcnt(1)
    s_add_u32 m0, s29, 16384
    s_add_u32 s32, s45, 14680064
    buffer_load_dwordx4 v15, s[12:15], s32 offen  lds
    v_mfma_f32_16x16x32_bf16 v[132:135], v[40:43], v[120:123], v[132:135]
    v_mfma_f32_16x16x32_bf16 v[136:139], v[44:47], v[120:123], v[136:139]
    buffer_load_dwordx4 v16, s[12:15], s32 offen offset:1024  lds
    v_mfma_f32_16x16x32_bf16 v[140:143], v[48:51], v[120:123], v[140:143]
    v_mfma_f32_16x16x32_bf16 v[144:147], v[36:39], v[124:127], v[144:147]
    buffer_load_dwordx4 v17, s[12:15], s32 offen offset:2048  lds
    v_mfma_f32_16x16x32_bf16 v[148:151], v[40:43], v[124:127], v[148:151]
    v_mfma_f32_16x16x32_bf16 v[152:155], v[44:47], v[124:127], v[152:155]
    buffer_load_dwordx4 v18, s[12:15], s32 offen offset:3072  lds
    v_mfma_f32_16x16x32_bf16 v[156:159], v[48:51], v[124:127], v[156:159]
    v_mfma_f32_16x16x32_bf16 v[160:163], v[36:39], v[84:87], v[160:163]
    s_waitcnt vmcnt(16)
    ds_read_b64_tr_b16 v[52:53], v11 offset:0
    v_mfma_f32_16x16x32_bf16 v[164:167], v[40:43], v[84:87], v[164:167]
    v_mfma_f32_16x16x32_bf16 v[168:171], v[44:47], v[84:87], v[168:171]
    ds_read_b64_tr_b16 v[54:55], v11 offset:512
    v_mfma_f32_16x16x32_bf16 v[172:175], v[48:51], v[84:87], v[172:175]
    v_mfma_f32_16x16x32_bf16 v[176:179], v[36:39], v[88:91], v[176:179]
    ds_read_b64_tr_b16 v[56:57], v12 offset:0
    v_mfma_f32_16x16x32_bf16 v[180:183], v[40:43], v[88:91], v[180:183]
    v_mfma_f32_16x16x32_bf16 v[184:187], v[44:47], v[88:91], v[184:187]
    ds_read_b64_tr_b16 v[58:59], v12 offset:512
    v_mfma_f32_16x16x32_bf16 v[188:191], v[48:51], v[88:91], v[188:191]
    v_mfma_f32_16x16x32_bf16 v[192:195], v[36:39], v[92:95], v[192:195]
    ds_read_b64_tr_b16 v[60:61], v13 offset:0
    v_mfma_f32_16x16x32_bf16 v[196:199], v[40:43], v[92:95], v[196:199]
    v_mfma_f32_16x16x32_bf16 v[200:203], v[44:47], v[92:95], v[200:203]
    ds_read_b64_tr_b16 v[62:63], v13 offset:512
    v_mfma_f32_16x16x32_bf16 v[204:207], v[48:51], v[92:95], v[204:207]
    v_mfma_f32_16x16x32_bf16 v[208:211], v[36:39], v[96:99], v[208:211]
    ds_read_b64_tr_b16 v[64:65], v14 offset:0
    v_mfma_f32_16x16x32_bf16 v[212:215], v[40:43], v[96:99], v[212:215]
    v_mfma_f32_16x16x32_bf16 v[216:219], v[44:47], v[96:99], v[216:219]
    ds_read_b64_tr_b16 v[66:67], v14 offset:512
    v_mfma_f32_16x16x32_bf16 v[220:223], v[48:51], v[96:99], v[220:223]
    v_mfma_f32_16x16x32_bf16 v[224:227], v[36:39], v[100:103], v[224:227]
    v_mfma_f32_16x16x32_bf16 v[228:231], v[40:43], v[100:103], v[228:231]
    v_mfma_f32_16x16x32_bf16 v[232:235], v[44:47], v[100:103], v[232:235]
    ds_read_b128 v[116:119], v30 offset:13824
    v_mfma_f32_16x16x32_bf16 v[236:239], v[48:51], v[100:103], v[236:239]
    v_mfma_f32_16x16x32_bf16 v[240:243], v[36:39], v[104:107], v[240:243]
    v_mfma_f32_16x16x32_bf16 v[244:247], v[40:43], v[104:107], v[244:247]
    v_mfma_f32_16x16x32_bf16 v[248:251], v[44:47], v[104:107], v[248:251]
    v_mfma_f32_16x16x32_bf16 v[252:255], v[48:51], v[104:107], v[252:255]
    s_waitcnt lgkmcnt(7)
    v_mfma_f32_16x16x32_bf16 v[128:131], v[52:55], v[124:127], v[128:131]
    s_waitcnt lgkmcnt(1)
    s_add_u32 m0, s29, 0
    s_add_u32 s32, s46, 0
    buffer_load_dwordx4 v15, s[12:15], s32 offen  lds
    v_mfma_f32_16x16x32_bf16 v[132:135], v[56:59], v[124:127], v[132:135]
    v_mfma_f32_16x16x32_bf16 v[136:139], v[60:63], v[124:127], v[136:139]
    buffer_load_dwordx4 v16, s[12:15], s32 offen offset:1024  lds
    v_mfma_f32_16x16x32_bf16 v[140:143], v[64:67], v[124:127], v[140:143]
    v_mfma_f32_16x16x32_bf16 v[144:147], v[52:55], v[84:87], v[144:147]
    buffer_load_dwordx4 v17, s[12:15], s32 offen offset:2048  lds
    v_mfma_f32_16x16x32_bf16 v[148:151], v[56:59], v[84:87], v[148:151]
    v_mfma_f32_16x16x32_bf16 v[152:155], v[60:63], v[84:87], v[152:155]
    buffer_load_dwordx4 v18, s[12:15], s32 offen offset:3072  lds
    v_mfma_f32_16x16x32_bf16 v[156:159], v[64:67], v[84:87], v[156:159]
    v_mfma_f32_16x16x32_bf16 v[160:163], v[52:55], v[88:91], v[160:163]
    s_waitcnt vmcnt(16)
    ds_read_b64_tr_b16 v[68:69], v11 offset:4096
    v_mfma_f32_16x16x32_bf16 v[164:167], v[56:59], v[88:91], v[164:167]
    v_mfma_f32_16x16x32_bf16 v[168:171], v[60:63], v[88:91], v[168:171]
    ds_read_b64_tr_b16 v[70:71], v11 offset:4608
    v_mfma_f32_16x16x32_bf16 v[172:175], v[64:67], v[88:91], v[172:175]
    v_mfma_f32_16x16x32_bf16 v[176:179], v[52:55], v[92:95], v[176:179]
    ds_read_b64_tr_b16 v[72:73], v12 offset:4096
    v_mfma_f32_16x16x32_bf16 v[180:183], v[56:59], v[92:95], v[180:183]
    v_mfma_f32_16x16x32_bf16 v[184:187], v[60:63], v[92:95], v[184:187]
    ds_read_b64_tr_b16 v[74:75], v12 offset:4608
    v_mfma_f32_16x16x32_bf16 v[188:191], v[64:67], v[92:95], v[188:191]
    v_mfma_f32_16x16x32_bf16 v[192:195], v[52:55], v[96:99], v[192:195]
    ds_read_b64_tr_b16 v[76:77], v13 offset:4096
    v_mfma_f32_16x16x32_bf16 v[196:199], v[56:59], v[96:99], v[196:199]
    v_mfma_f32_16x16x32_bf16 v[200:203], v[60:63], v[96:99], v[200:203]
    ds_read_b64_tr_b16 v[78:79], v13 offset:4608
    v_mfma_f32_16x16x32_bf16 v[204:207], v[64:67], v[96:99], v[204:207]
    v_mfma_f32_16x16x32_bf16 v[208:211], v[52:55], v[100:103], v[208:211]
    ds_read_b64_tr_b16 v[80:81], v14 offset:4096
    v_mfma_f32_16x16x32_bf16 v[212:215], v[56:59], v[100:103], v[212:215]
    v_mfma_f32_16x16x32_bf16 v[216:219], v[60:63], v[100:103], v[216:219]
    ds_read_b64_tr_b16 v[82:83], v14 offset:4608
    v_mfma_f32_16x16x32_bf16 v[220:223], v[64:67], v[100:103], v[220:223]
    v_mfma_f32_16x16x32_bf16 v[224:227], v[52:55], v[104:107], v[224:227]
    v_mfma_f32_16x16x32_bf16 v[228:231], v[56:59], v[104:107], v[228:231]
    v_mfma_f32_16x16x32_bf16 v[232:235], v[60:63], v[104:107], v[232:235]
    ds_read_b128 v[120:123], v30 offset:18432
    v_mfma_f32_16x16x32_bf16 v[236:239], v[64:67], v[104:107], v[236:239]
    v_mfma_f32_16x16x32_bf16 v[240:243], v[52:55], v[108:111], v[240:243]
    v_mfma_f32_16x16x32_bf16 v[244:247], v[56:59], v[108:111], v[244:247]
    v_mfma_f32_16x16x32_bf16 v[248:251], v[60:63], v[108:111], v[248:251]
    v_mfma_f32_16x16x32_bf16 v[252:255], v[64:67], v[108:111], v[252:255]
    s_waitcnt lgkmcnt(7)
    v_mfma_f32_16x16x32_bf16 v[128:131], v[68:71], v[84:87], v[128:131]
    s_waitcnt lgkmcnt(1)
    s_add_u32 m0, s29, 4096
    s_add_u32 s32, s46, 1048576
    buffer_load_dwordx4 v15, s[12:15], s32 offen  lds
    v_mfma_f32_16x16x32_bf16 v[132:135], v[72:75], v[84:87], v[132:135]
    v_mfma_f32_16x16x32_bf16 v[136:139], v[76:79], v[84:87], v[136:139]
    buffer_load_dwordx4 v16, s[12:15], s32 offen offset:1024  lds
    v_mfma_f32_16x16x32_bf16 v[140:143], v[80:83], v[84:87], v[140:143]
    v_mfma_f32_16x16x32_bf16 v[144:147], v[68:71], v[88:91], v[144:147]
    buffer_load_dwordx4 v17, s[12:15], s32 offen offset:2048  lds
    v_mfma_f32_16x16x32_bf16 v[148:151], v[72:75], v[88:91], v[148:151]
    v_mfma_f32_16x16x32_bf16 v[152:155], v[76:79], v[88:91], v[152:155]
    buffer_load_dwordx4 v18, s[12:15], s32 offen offset:3072  lds
    v_mfma_f32_16x16x32_bf16 v[156:159], v[80:83], v[88:91], v[156:159]
    v_mfma_f32_16x16x32_bf16 v[160:163], v[68:71], v[92:95], v[160:163]
    s_waitcnt vmcnt(16)
    ds_read_b64_tr_b16 v[36:37], v11 offset:8192
    v_mfma_f32_16x16x32_bf16 v[164:167], v[72:75], v[92:95], v[164:167]
    v_mfma_f32_16x16x32_bf16 v[168:171], v[76:79], v[92:95], v[168:171]
    ds_read_b64_tr_b16 v[38:39], v11 offset:8704
    v_mfma_f32_16x16x32_bf16 v[172:175], v[80:83], v[92:95], v[172:175]
    v_mfma_f32_16x16x32_bf16 v[176:179], v[68:71], v[96:99], v[176:179]
    ds_read_b64_tr_b16 v[40:41], v12 offset:8192
    v_mfma_f32_16x16x32_bf16 v[180:183], v[72:75], v[96:99], v[180:183]
    v_mfma_f32_16x16x32_bf16 v[184:187], v[76:79], v[96:99], v[184:187]
    ds_read_b64_tr_b16 v[42:43], v12 offset:8704
    v_mfma_f32_16x16x32_bf16 v[188:191], v[80:83], v[96:99], v[188:191]
    v_mfma_f32_16x16x32_bf16 v[192:195], v[68:71], v[100:103], v[192:195]
    ds_read_b64_tr_b16 v[44:45], v13 offset:8192
    v_mfma_f32_16x16x32_bf16 v[196:199], v[72:75], v[100:103], v[196:199]
    v_mfma_f32_16x16x32_bf16 v[200:203], v[76:79], v[100:103], v[200:203]
    ds_read_b64_tr_b16 v[46:47], v13 offset:8704
    v_mfma_f32_16x16x32_bf16 v[204:207], v[80:83], v[100:103], v[204:207]
    v_mfma_f32_16x16x32_bf16 v[208:211], v[68:71], v[104:107], v[208:211]
    ds_read_b64_tr_b16 v[48:49], v14 offset:8192
    v_mfma_f32_16x16x32_bf16 v[212:215], v[72:75], v[104:107], v[212:215]
    v_mfma_f32_16x16x32_bf16 v[216:219], v[76:79], v[104:107], v[216:219]
    ds_read_b64_tr_b16 v[50:51], v14 offset:8704
    v_mfma_f32_16x16x32_bf16 v[220:223], v[80:83], v[104:107], v[220:223]
    v_mfma_f32_16x16x32_bf16 v[224:227], v[68:71], v[108:111], v[224:227]
    v_mfma_f32_16x16x32_bf16 v[228:231], v[72:75], v[108:111], v[228:231]
    v_mfma_f32_16x16x32_bf16 v[232:235], v[76:79], v[108:111], v[232:235]
    ds_read_b128 v[124:127], v30 offset:23040
    v_mfma_f32_16x16x32_bf16 v[236:239], v[80:83], v[108:111], v[236:239]
    v_mfma_f32_16x16x32_bf16 v[240:243], v[68:71], v[112:115], v[240:243]
    v_mfma_f32_16x16x32_bf16 v[244:247], v[72:75], v[112:115], v[244:247]
    v_mfma_f32_16x16x32_bf16 v[248:251], v[76:79], v[112:115], v[248:251]
    v_mfma_f32_16x16x32_bf16 v[252:255], v[80:83], v[112:115], v[252:255]
    s_waitcnt lgkmcnt(7)
    v_mfma_f32_16x16x32_bf16 v[128:131], v[36:39], v[88:91], v[128:131]
    s_waitcnt lgkmcnt(1)
    s_add_u32 m0, s29, 8192
    s_add_u32 s32, s46, 2097152
    buffer_load_dwordx4 v15, s[12:15], s32 offen  lds
    v_mfma_f32_16x16x32_bf16 v[132:135], v[40:43], v[88:91], v[132:135]
    v_mfma_f32_16x16x32_bf16 v[136:139], v[44:47], v[88:91], v[136:139]
    buffer_load_dwordx4 v16, s[12:15], s32 offen offset:1024  lds
    v_mfma_f32_16x16x32_bf16 v[140:143], v[48:51], v[88:91], v[140:143]
    v_mfma_f32_16x16x32_bf16 v[144:147], v[36:39], v[92:95], v[144:147]
    buffer_load_dwordx4 v17, s[12:15], s32 offen offset:2048  lds
    v_mfma_f32_16x16x32_bf16 v[148:151], v[40:43], v[92:95], v[148:151]
    v_mfma_f32_16x16x32_bf16 v[152:155], v[44:47], v[92:95], v[152:155]
    buffer_load_dwordx4 v18, s[12:15], s32 offen offset:3072  lds
    v_mfma_f32_16x16x32_bf16 v[156:159], v[48:51], v[92:95], v[156:159]
    v_mfma_f32_16x16x32_bf16 v[160:163], v[36:39], v[96:99], v[160:163]
    s_waitcnt vmcnt(16)
    ds_read_b64_tr_b16 v[52:53], v11 offset:12288
    v_mfma_f32_16x16x32_bf16 v[164:167], v[40:43], v[96:99], v[164:167]
    v_mfma_f32_16x16x32_bf16 v[168:171], v[44:47], v[96:99], v[168:171]
    ds_read_b64_tr_b16 v[54:55], v11 offset:12800
    v_mfma_f32_16x16x32_bf16 v[172:175], v[48:51], v[96:99], v[172:175]
    v_mfma_f32_16x16x32_bf16 v[176:179], v[36:39], v[100:103], v[176:179]
    ds_read_b64_tr_b16 v[56:57], v12 offset:12288
    v_mfma_f32_16x16x32_bf16 v[180:183], v[40:43], v[100:103], v[180:183]
    v_mfma_f32_16x16x32_bf16 v[184:187], v[44:47], v[100:103], v[184:187]
    ds_read_b64_tr_b16 v[58:59], v12 offset:12800
    v_mfma_f32_16x16x32_bf16 v[188:191], v[48:51], v[100:103], v[188:191]
    v_mfma_f32_16x16x32_bf16 v[192:195], v[36:39], v[104:107], v[192:195]
    ds_read_b64_tr_b16 v[60:61], v13 offset:12288
    v_mfma_f32_16x16x32_bf16 v[196:199], v[40:43], v[104:107], v[196:199]
    v_mfma_f32_16x16x32_bf16 v[200:203], v[44:47], v[104:107], v[200:203]
    ds_read_b64_tr_b16 v[62:63], v13 offset:12800
    v_mfma_f32_16x16x32_bf16 v[204:207], v[48:51], v[104:107], v[204:207]
    v_mfma_f32_16x16x32_bf16 v[208:211], v[36:39], v[108:111], v[208:211]
    ds_read_b64_tr_b16 v[64:65], v14 offset:12288
    s_waitcnt lgkmcnt(7)
    s_barrier
    v_mfma_f32_16x16x32_bf16 v[212:215], v[40:43], v[108:111], v[212:215]
    v_mfma_f32_16x16x32_bf16 v[216:219], v[44:47], v[108:111], v[216:219]
    ds_read_b64_tr_b16 v[66:67], v14 offset:12800
    ds_read_b128 v[84:87], v8 offset:0
    v_mfma_f32_16x16x32_bf16 v[220:223], v[48:51], v[108:111], v[220:223]
    v_mfma_f32_16x16x32_bf16 v[224:227], v[36:39], v[112:115], v[224:227]
    v_mfma_f32_16x16x32_bf16 v[228:231], v[40:43], v[112:115], v[228:231]
    v_mfma_f32_16x16x32_bf16 v[232:235], v[44:47], v[112:115], v[232:235]
    v_mfma_f32_16x16x32_bf16 v[236:239], v[48:51], v[112:115], v[236:239]
    v_mfma_f32_16x16x32_bf16 v[240:243], v[36:39], v[116:119], v[240:243]
    v_mfma_f32_16x16x32_bf16 v[244:247], v[40:43], v[116:119], v[244:247]
    v_mfma_f32_16x16x32_bf16 v[248:251], v[44:47], v[116:119], v[248:251]
    v_mfma_f32_16x16x32_bf16 v[252:255], v[48:51], v[116:119], v[252:255]
    s_waitcnt lgkmcnt(7)
    v_mfma_f32_16x16x32_bf16 v[128:131], v[52:55], v[92:95], v[128:131]
    s_waitcnt lgkmcnt(1)
    s_add_u32 m0, s29, 12288
    s_add_u32 s32, s46, 3145728
    buffer_load_dwordx4 v15, s[12:15], s32 offen  lds
    v_mfma_f32_16x16x32_bf16 v[132:135], v[56:59], v[92:95], v[132:135]
    v_mfma_f32_16x16x32_bf16 v[136:139], v[60:63], v[92:95], v[136:139]
    buffer_load_dwordx4 v16, s[12:15], s32 offen offset:1024  lds
    v_mfma_f32_16x16x32_bf16 v[140:143], v[64:67], v[92:95], v[140:143]
    v_mfma_f32_16x16x32_bf16 v[144:147], v[52:55], v[96:99], v[144:147]
    buffer_load_dwordx4 v17, s[12:15], s32 offen offset:2048  lds
    v_mfma_f32_16x16x32_bf16 v[148:151], v[56:59], v[96:99], v[148:151]
    ds_read_b128 v[88:91], v8 offset:4608
    v_mfma_f32_16x16x32_bf16 v[152:155], v[60:63], v[96:99], v[152:155]
    buffer_load_dwordx4 v18, s[12:15], s32 offen offset:3072  lds
    v_mfma_f32_16x16x32_bf16 v[156:159], v[64:67], v[96:99], v[156:159]
    v_mfma_f32_16x16x32_bf16 v[160:163], v[52:55], v[100:103], v[160:163]
    s_waitcnt vmcnt(16)
    ds_read_b64_tr_b16 v[68:69], v11 offset:16384
    v_mfma_f32_16x16x32_bf16 v[164:167], v[56:59], v[100:103], v[164:167]
    v_mfma_f32_16x16x32_bf16 v[168:171], v[60:63], v[100:103], v[168:171]
    ds_read_b64_tr_b16 v[70:71], v11 offset:16896
    v_mfma_f32_16x16x32_bf16 v[172:175], v[64:67], v[100:103], v[172:175]
    v_mfma_f32_16x16x32_bf16 v[176:179], v[52:55], v[104:107], v[176:179]
    ds_read_b64_tr_b16 v[72:73], v12 offset:16384
    v_mfma_f32_16x16x32_bf16 v[180:183], v[56:59], v[104:107], v[180:183]
    v_mfma_f32_16x16x32_bf16 v[184:187], v[60:63], v[104:107], v[184:187]
    ds_read_b64_tr_b16 v[74:75], v12 offset:16896
    v_mfma_f32_16x16x32_bf16 v[188:191], v[64:67], v[104:107], v[188:191]
    v_mfma_f32_16x16x32_bf16 v[192:195], v[52:55], v[108:111], v[192:195]
    ds_read_b64_tr_b16 v[76:77], v13 offset:16384
    v_mfma_f32_16x16x32_bf16 v[196:199], v[56:59], v[108:111], v[196:199]
    v_mfma_f32_16x16x32_bf16 v[200:203], v[60:63], v[108:111], v[200:203]
    ds_read_b64_tr_b16 v[78:79], v13 offset:16896
    v_mfma_f32_16x16x32_bf16 v[204:207], v[64:67], v[108:111], v[204:207]
    v_mfma_f32_16x16x32_bf16 v[208:211], v[52:55], v[112:115], v[208:211]
    ds_read_b64_tr_b16 v[80:81], v14 offset:16384
    v_mfma_f32_16x16x32_bf16 v[212:215], v[56:59], v[112:115], v[212:215]
    v_mfma_f32_16x16x32_bf16 v[216:219], v[60:63], v[112:115], v[216:219]
    ds_read_b64_tr_b16 v[82:83], v14 offset:16896
    v_mfma_f32_16x16x32_bf16 v[220:223], v[64:67], v[112:115], v[220:223]
    v_mfma_f32_16x16x32_bf16 v[224:227], v[52:55], v[116:119], v[224:227]
    ds_read_b128 v[92:95], v8 offset:9216
    v_mfma_f32_16x16x32_bf16 v[228:231], v[56:59], v[116:119], v[228:231]
    v_mfma_f32_16x16x32_bf16 v[232:235], v[60:63], v[116:119], v[232:235]
    v_mfma_f32_16x16x32_bf16 v[236:239], v[64:67], v[116:119], v[236:239]
    v_mfma_f32_16x16x32_bf16 v[240:243], v[52:55], v[120:123], v[240:243]
    v_mfma_f32_16x16x32_bf16 v[244:247], v[56:59], v[120:123], v[244:247]
    v_mfma_f32_16x16x32_bf16 v[248:251], v[60:63], v[120:123], v[248:251]
    v_mfma_f32_16x16x32_bf16 v[252:255], v[64:67], v[120:123], v[252:255]
    s_waitcnt lgkmcnt(7)
    v_mfma_f32_16x16x32_bf16 v[128:131], v[68:71], v[96:99], v[128:131]
    s_waitcnt lgkmcnt(1)
    s_add_u32 m0, s29, 16384
    s_add_u32 s32, s46, 4194304
    buffer_load_dwordx4 v15, s[12:15], s32 offen  lds
    v_mfma_f32_16x16x32_bf16 v[132:135], v[72:75], v[96:99], v[132:135]
    v_mfma_f32_16x16x32_bf16 v[136:139], v[76:79], v[96:99], v[136:139]
    buffer_load_dwordx4 v16, s[12:15], s32 offen offset:1024  lds
    v_mfma_f32_16x16x32_bf16 v[140:143], v[80:83], v[96:99], v[140:143]
    ds_read_b128 v[96:99], v8 offset:13824
    v_mfma_f32_16x16x32_bf16 v[144:147], v[68:71], v[100:103], v[144:147]
    buffer_load_dwordx4 v17, s[12:15], s32 offen offset:2048  lds
    v_mfma_f32_16x16x32_bf16 v[148:151], v[72:75], v[100:103], v[148:151]
    v_mfma_f32_16x16x32_bf16 v[152:155], v[76:79], v[100:103], v[152:155]
    buffer_load_dwordx4 v18, s[12:15], s32 offen offset:3072  lds
    v_mfma_f32_16x16x32_bf16 v[156:159], v[80:83], v[100:103], v[156:159]
    ds_read_b128 v[100:103], v8 offset:18432
    v_mfma_f32_16x16x32_bf16 v[160:163], v[68:71], v[104:107], v[160:163]
    s_waitcnt vmcnt(16)
    ds_read_b64_tr_b16 v[36:37], v11 offset:0
    v_mfma_f32_16x16x32_bf16 v[164:167], v[72:75], v[104:107], v[164:167]
    v_mfma_f32_16x16x32_bf16 v[168:171], v[76:79], v[104:107], v[168:171]
    ds_read_b64_tr_b16 v[38:39], v11 offset:512
    v_mfma_f32_16x16x32_bf16 v[172:175], v[80:83], v[104:107], v[172:175]
    ds_read_b128 v[104:107], v8 offset:23040
    v_mfma_f32_16x16x32_bf16 v[176:179], v[68:71], v[108:111], v[176:179]
    ds_read_b64_tr_b16 v[40:41], v12 offset:0
    v_mfma_f32_16x16x32_bf16 v[180:183], v[72:75], v[108:111], v[180:183]
    v_mfma_f32_16x16x32_bf16 v[184:187], v[76:79], v[108:111], v[184:187]
    ds_read_b64_tr_b16 v[42:43], v12 offset:512
    v_mfma_f32_16x16x32_bf16 v[188:191], v[80:83], v[108:111], v[188:191]
    ds_read_b128 v[108:111], v8 offset:27648
    v_mfma_f32_16x16x32_bf16 v[192:195], v[68:71], v[112:115], v[192:195]
    ds_read_b64_tr_b16 v[44:45], v13 offset:0
    v_mfma_f32_16x16x32_bf16 v[196:199], v[72:75], v[112:115], v[196:199]
    v_mfma_f32_16x16x32_bf16 v[200:203], v[76:79], v[112:115], v[200:203]
    ds_read_b64_tr_b16 v[46:47], v13 offset:512
    v_mfma_f32_16x16x32_bf16 v[204:207], v[80:83], v[112:115], v[204:207]
    ds_read_b128 v[112:115], v8 offset:32256
    v_mfma_f32_16x16x32_bf16 v[208:211], v[68:71], v[116:119], v[208:211]
    ds_read_b64_tr_b16 v[48:49], v14 offset:0
    v_mfma_f32_16x16x32_bf16 v[212:215], v[72:75], v[116:119], v[212:215]
    v_mfma_f32_16x16x32_bf16 v[216:219], v[76:79], v[116:119], v[216:219]
    ds_read_b64_tr_b16 v[50:51], v14 offset:512
    v_mfma_f32_16x16x32_bf16 v[220:223], v[80:83], v[116:119], v[220:223]
    ds_read_b128 v[116:119], v9 offset:0
    v_mfma_f32_16x16x32_bf16 v[224:227], v[68:71], v[120:123], v[224:227]
    v_mfma_f32_16x16x32_bf16 v[228:231], v[72:75], v[120:123], v[228:231]
    v_mfma_f32_16x16x32_bf16 v[232:235], v[76:79], v[120:123], v[232:235]
    v_mfma_f32_16x16x32_bf16 v[236:239], v[80:83], v[120:123], v[236:239]
    ds_read_b128 v[120:123], v9 offset:4608
    v_mfma_f32_16x16x32_bf16 v[240:243], v[68:71], v[124:127], v[240:243]
    v_mfma_f32_16x16x32_bf16 v[244:247], v[72:75], v[124:127], v[244:247]
    v_mfma_f32_16x16x32_bf16 v[248:251], v[76:79], v[124:127], v[248:251]
    v_mfma_f32_16x16x32_bf16 v[252:255], v[80:83], v[124:127], v[252:255]
    s_waitcnt lgkmcnt(11)
    v_mfma_f32_16x16x32_bf16 v[128:131], v[36:39], v[84:87], v[128:131]
    s_waitcnt lgkmcnt(2)
    s_add_u32 m0, s29, 0
    s_add_u32 s32, s46, 5242880
    buffer_load_dwordx4 v15, s[12:15], s32 offen  lds
    v_mfma_f32_16x16x32_bf16 v[132:135], v[40:43], v[84:87], v[132:135]
    v_mfma_f32_16x16x32_bf16 v[136:139], v[44:47], v[84:87], v[136:139]
    buffer_load_dwordx4 v16, s[12:15], s32 offen offset:1024  lds
    v_mfma_f32_16x16x32_bf16 v[140:143], v[48:51], v[84:87], v[140:143]
    v_mfma_f32_16x16x32_bf16 v[144:147], v[36:39], v[88:91], v[144:147]
    buffer_load_dwordx4 v17, s[12:15], s32 offen offset:2048  lds
    v_mfma_f32_16x16x32_bf16 v[148:151], v[40:43], v[88:91], v[148:151]
    v_mfma_f32_16x16x32_bf16 v[152:155], v[44:47], v[88:91], v[152:155]
    buffer_load_dwordx4 v18, s[12:15], s32 offen offset:3072  lds
    v_mfma_f32_16x16x32_bf16 v[156:159], v[48:51], v[88:91], v[156:159]
    v_mfma_f32_16x16x32_bf16 v[160:163], v[36:39], v[92:95], v[160:163]
    s_waitcnt vmcnt(16)
    ds_read_b64_tr_b16 v[52:53], v11 offset:4096
    v_mfma_f32_16x16x32_bf16 v[164:167], v[40:43], v[92:95], v[164:167]
    v_mfma_f32_16x16x32_bf16 v[168:171], v[44:47], v[92:95], v[168:171]
    ds_read_b64_tr_b16 v[54:55], v11 offset:4608
    v_mfma_f32_16x16x32_bf16 v[172:175], v[48:51], v[92:95], v[172:175]
    v_mfma_f32_16x16x32_bf16 v[176:179], v[36:39], v[96:99], v[176:179]
    ds_read_b64_tr_b16 v[56:57], v12 offset:4096
    v_mfma_f32_16x16x32_bf16 v[180:183], v[40:43], v[96:99], v[180:183]
    v_mfma_f32_16x16x32_bf16 v[184:187], v[44:47], v[96:99], v[184:187]
    ds_read_b64_tr_b16 v[58:59], v12 offset:4608
    v_mfma_f32_16x16x32_bf16 v[188:191], v[48:51], v[96:99], v[188:191]
    v_mfma_f32_16x16x32_bf16 v[192:195], v[36:39], v[100:103], v[192:195]
    ds_read_b64_tr_b16 v[60:61], v13 offset:4096
    v_mfma_f32_16x16x32_bf16 v[196:199], v[40:43], v[100:103], v[196:199]
    v_mfma_f32_16x16x32_bf16 v[200:203], v[44:47], v[100:103], v[200:203]
    ds_read_b64_tr_b16 v[62:63], v13 offset:4608
    v_mfma_f32_16x16x32_bf16 v[204:207], v[48:51], v[100:103], v[204:207]
    v_mfma_f32_16x16x32_bf16 v[208:211], v[36:39], v[104:107], v[208:211]
    ds_read_b64_tr_b16 v[64:65], v14 offset:4096
    v_mfma_f32_16x16x32_bf16 v[212:215], v[40:43], v[104:107], v[212:215]
    v_mfma_f32_16x16x32_bf16 v[216:219], v[44:47], v[104:107], v[216:219]
    ds_read_b64_tr_b16 v[66:67], v14 offset:4608
    v_mfma_f32_16x16x32_bf16 v[220:223], v[48:51], v[104:107], v[220:223]
    v_mfma_f32_16x16x32_bf16 v[224:227], v[36:39], v[108:111], v[224:227]
    v_mfma_f32_16x16x32_bf16 v[228:231], v[40:43], v[108:111], v[228:231]
    v_mfma_f32_16x16x32_bf16 v[232:235], v[44:47], v[108:111], v[232:235]
    ds_read_b128 v[124:127], v9 offset:9216
    v_mfma_f32_16x16x32_bf16 v[236:239], v[48:51], v[108:111], v[236:239]
    v_mfma_f32_16x16x32_bf16 v[240:243], v[36:39], v[112:115], v[240:243]
    v_mfma_f32_16x16x32_bf16 v[244:247], v[40:43], v[112:115], v[244:247]
    v_mfma_f32_16x16x32_bf16 v[248:251], v[44:47], v[112:115], v[248:251]
    v_mfma_f32_16x16x32_bf16 v[252:255], v[48:51], v[112:115], v[252:255]
    s_waitcnt lgkmcnt(7)
    v_mfma_f32_16x16x32_bf16 v[128:131], v[52:55], v[88:91], v[128:131]
    s_waitcnt lgkmcnt(1)
    s_add_u32 m0, s29, 4096
    s_add_u32 s32, s46, 6291456
    buffer_load_dwordx4 v15, s[12:15], s32 offen  lds
    v_mfma_f32_16x16x32_bf16 v[132:135], v[56:59], v[88:91], v[132:135]
    v_mfma_f32_16x16x32_bf16 v[136:139], v[60:63], v[88:91], v[136:139]
    buffer_load_dwordx4 v16, s[12:15], s32 offen offset:1024  lds
    v_mfma_f32_16x16x32_bf16 v[140:143], v[64:67], v[88:91], v[140:143]
    v_mfma_f32_16x16x32_bf16 v[144:147], v[52:55], v[92:95], v[144:147]
    buffer_load_dwordx4 v17, s[12:15], s32 offen offset:2048  lds
    v_mfma_f32_16x16x32_bf16 v[148:151], v[56:59], v[92:95], v[148:151]
    v_mfma_f32_16x16x32_bf16 v[152:155], v[60:63], v[92:95], v[152:155]
    buffer_load_dwordx4 v18, s[12:15], s32 offen offset:3072  lds
    v_mfma_f32_16x16x32_bf16 v[156:159], v[64:67], v[92:95], v[156:159]
    v_mfma_f32_16x16x32_bf16 v[160:163], v[52:55], v[96:99], v[160:163]
    s_waitcnt vmcnt(16)
    ds_read_b64_tr_b16 v[68:69], v11 offset:8192
    v_mfma_f32_16x16x32_bf16 v[164:167], v[56:59], v[96:99], v[164:167]
    v_mfma_f32_16x16x32_bf16 v[168:171], v[60:63], v[96:99], v[168:171]
    ds_read_b64_tr_b16 v[70:71], v11 offset:8704
    v_mfma_f32_16x16x32_bf16 v[172:175], v[64:67], v[96:99], v[172:175]
    v_mfma_f32_16x16x32_bf16 v[176:179], v[52:55], v[100:103], v[176:179]
    ds_read_b64_tr_b16 v[72:73], v12 offset:8192
    v_mfma_f32_16x16x32_bf16 v[180:183], v[56:59], v[100:103], v[180:183]
    v_mfma_f32_16x16x32_bf16 v[184:187], v[60:63], v[100:103], v[184:187]
    ds_read_b64_tr_b16 v[74:75], v12 offset:8704
    v_mfma_f32_16x16x32_bf16 v[188:191], v[64:67], v[100:103], v[188:191]
    v_mfma_f32_16x16x32_bf16 v[192:195], v[52:55], v[104:107], v[192:195]
    ds_read_b64_tr_b16 v[76:77], v13 offset:8192
    v_mfma_f32_16x16x32_bf16 v[196:199], v[56:59], v[104:107], v[196:199]
    v_mfma_f32_16x16x32_bf16 v[200:203], v[60:63], v[104:107], v[200:203]
    ds_read_b64_tr_b16 v[78:79], v13 offset:8704
    v_mfma_f32_16x16x32_bf16 v[204:207], v[64:67], v[104:107], v[204:207]
    v_mfma_f32_16x16x32_bf16 v[208:211], v[52:55], v[108:111], v[208:211]
    ds_read_b64_tr_b16 v[80:81], v14 offset:8192
    v_mfma_f32_16x16x32_bf16 v[212:215], v[56:59], v[108:111], v[212:215]
    v_mfma_f32_16x16x32_bf16 v[216:219], v[60:63], v[108:111], v[216:219]
    ds_read_b64_tr_b16 v[82:83], v14 offset:8704
    v_mfma_f32_16x16x32_bf16 v[220:223], v[64:67], v[108:111], v[220:223]
    v_mfma_f32_16x16x32_bf16 v[224:227], v[52:55], v[112:115], v[224:227]
    v_mfma_f32_16x16x32_bf16 v[228:231], v[56:59], v[112:115], v[228:231]
    v_mfma_f32_16x16x32_bf16 v[232:235], v[60:63], v[112:115], v[232:235]
    ds_read_b128 v[84:87], v9 offset:13824
    v_mfma_f32_16x16x32_bf16 v[236:239], v[64:67], v[112:115], v[236:239]
    v_mfma_f32_16x16x32_bf16 v[240:243], v[52:55], v[116:119], v[240:243]
    v_mfma_f32_16x16x32_bf16 v[244:247], v[56:59], v[116:119], v[244:247]
    v_mfma_f32_16x16x32_bf16 v[248:251], v[60:63], v[116:119], v[248:251]
    v_mfma_f32_16x16x32_bf16 v[252:255], v[64:67], v[116:119], v[252:255]
    s_waitcnt lgkmcnt(7)
    v_mfma_f32_16x16x32_bf16 v[128:131], v[68:71], v[92:95], v[128:131]
    s_waitcnt lgkmcnt(1)
    s_add_u32 m0, s29, 8192
    s_add_u32 s32, s46, 7340032
    buffer_load_dwordx4 v15, s[12:15], s32 offen  lds
    v_mfma_f32_16x16x32_bf16 v[132:135], v[72:75], v[92:95], v[132:135]
    v_mfma_f32_16x16x32_bf16 v[136:139], v[76:79], v[92:95], v[136:139]
    buffer_load_dwordx4 v16, s[12:15], s32 offen offset:1024  lds
    v_mfma_f32_16x16x32_bf16 v[140:143], v[80:83], v[92:95], v[140:143]
    v_mfma_f32_16x16x32_bf16 v[144:147], v[68:71], v[96:99], v[144:147]
    buffer_load_dwordx4 v17, s[12:15], s32 offen offset:2048  lds
    v_mfma_f32_16x16x32_bf16 v[148:151], v[72:75], v[96:99], v[148:151]
    v_mfma_f32_16x16x32_bf16 v[152:155], v[76:79], v[96:99], v[152:155]
    buffer_load_dwordx4 v18, s[12:15], s32 offen offset:3072  lds
    v_mfma_f32_16x16x32_bf16 v[156:159], v[80:83], v[96:99], v[156:159]
    v_mfma_f32_16x16x32_bf16 v[160:163], v[68:71], v[100:103], v[160:163]
    s_waitcnt vmcnt(16)
    ds_read_b64_tr_b16 v[36:37], v11 offset:12288
    v_mfma_f32_16x16x32_bf16 v[164:167], v[72:75], v[100:103], v[164:167]
    v_mfma_f32_16x16x32_bf16 v[168:171], v[76:79], v[100:103], v[168:171]
    ds_read_b64_tr_b16 v[38:39], v11 offset:12800
    v_mfma_f32_16x16x32_bf16 v[172:175], v[80:83], v[100:103], v[172:175]
    v_mfma_f32_16x16x32_bf16 v[176:179], v[68:71], v[104:107], v[176:179]
    ds_read_b64_tr_b16 v[40:41], v12 offset:12288
    v_mfma_f32_16x16x32_bf16 v[180:183], v[72:75], v[104:107], v[180:183]
    v_mfma_f32_16x16x32_bf16 v[184:187], v[76:79], v[104:107], v[184:187]
    ds_read_b64_tr_b16 v[42:43], v12 offset:12800
    v_mfma_f32_16x16x32_bf16 v[188:191], v[80:83], v[104:107], v[188:191]
    v_mfma_f32_16x16x32_bf16 v[192:195], v[68:71], v[108:111], v[192:195]
    ds_read_b64_tr_b16 v[44:45], v13 offset:12288
    v_mfma_f32_16x16x32_bf16 v[196:199], v[72:75], v[108:111], v[196:199]
    v_mfma_f32_16x16x32_bf16 v[200:203], v[76:79], v[108:111], v[200:203]
    ds_read_b64_tr_b16 v[46:47], v13 offset:12800
    v_mfma_f32_16x16x32_bf16 v[204:207], v[80:83], v[108:111], v[204:207]
    v_mfma_f32_16x16x32_bf16 v[208:211], v[68:71], v[112:115], v[208:211]
    ds_read_b64_tr_b16 v[48:49], v14 offset:12288
    v_mfma_f32_16x16x32_bf16 v[212:215], v[72:75], v[112:115], v[212:215]
    v_mfma_f32_16x16x32_bf16 v[216:219], v[76:79], v[112:115], v[216:219]
    ds_read_b64_tr_b16 v[50:51], v14 offset:12800
    v_mfma_f32_16x16x32_bf16 v[220:223], v[80:83], v[112:115], v[220:223]
    v_mfma_f32_16x16x32_bf16 v[224:227], v[68:71], v[116:119], v[224:227]
    v_mfma_f32_16x16x32_bf16 v[228:231], v[72:75], v[116:119], v[228:231]
    v_mfma_f32_16x16x32_bf16 v[232:235], v[76:79], v[116:119], v[232:235]
    ds_read_b128 v[88:91], v9 offset:18432
    v_mfma_f32_16x16x32_bf16 v[236:239], v[80:83], v[116:119], v[236:239]
    v_mfma_f32_16x16x32_bf16 v[240:243], v[68:71], v[120:123], v[240:243]
    v_mfma_f32_16x16x32_bf16 v[244:247], v[72:75], v[120:123], v[244:247]
    v_mfma_f32_16x16x32_bf16 v[248:251], v[76:79], v[120:123], v[248:251]
    v_mfma_f32_16x16x32_bf16 v[252:255], v[80:83], v[120:123], v[252:255]
    s_waitcnt lgkmcnt(7)
    v_mfma_f32_16x16x32_bf16 v[128:131], v[36:39], v[96:99], v[128:131]
    s_waitcnt lgkmcnt(1)
    s_add_u32 m0, s29, 12288
    s_add_u32 s32, s46, 8388608
    buffer_load_dwordx4 v15, s[12:15], s32 offen  lds
    v_mfma_f32_16x16x32_bf16 v[132:135], v[40:43], v[96:99], v[132:135]
    v_mfma_f32_16x16x32_bf16 v[136:139], v[44:47], v[96:99], v[136:139]
    buffer_load_dwordx4 v16, s[12:15], s32 offen offset:1024  lds
    v_mfma_f32_16x16x32_bf16 v[140:143], v[48:51], v[96:99], v[140:143]
    v_mfma_f32_16x16x32_bf16 v[144:147], v[36:39], v[100:103], v[144:147]
    buffer_load_dwordx4 v17, s[12:15], s32 offen offset:2048  lds
    v_mfma_f32_16x16x32_bf16 v[148:151], v[40:43], v[100:103], v[148:151]
    v_mfma_f32_16x16x32_bf16 v[152:155], v[44:47], v[100:103], v[152:155]
    buffer_load_dwordx4 v18, s[12:15], s32 offen offset:3072  lds
    v_mfma_f32_16x16x32_bf16 v[156:159], v[48:51], v[100:103], v[156:159]
    v_mfma_f32_16x16x32_bf16 v[160:163], v[36:39], v[104:107], v[160:163]
    s_waitcnt vmcnt(16)
    ds_read_b64_tr_b16 v[52:53], v11 offset:16384
    v_mfma_f32_16x16x32_bf16 v[164:167], v[40:43], v[104:107], v[164:167]
    v_mfma_f32_16x16x32_bf16 v[168:171], v[44:47], v[104:107], v[168:171]
    ds_read_b64_tr_b16 v[54:55], v11 offset:16896
    v_mfma_f32_16x16x32_bf16 v[172:175], v[48:51], v[104:107], v[172:175]
    v_mfma_f32_16x16x32_bf16 v[176:179], v[36:39], v[108:111], v[176:179]
    ds_read_b64_tr_b16 v[56:57], v12 offset:16384
    v_mfma_f32_16x16x32_bf16 v[180:183], v[40:43], v[108:111], v[180:183]
    v_mfma_f32_16x16x32_bf16 v[184:187], v[44:47], v[108:111], v[184:187]
    ds_read_b64_tr_b16 v[58:59], v12 offset:16896
    v_mfma_f32_16x16x32_bf16 v[188:191], v[48:51], v[108:111], v[188:191]
    v_mfma_f32_16x16x32_bf16 v[192:195], v[36:39], v[112:115], v[192:195]
    ds_read_b64_tr_b16 v[60:61], v13 offset:16384
    v_mfma_f32_16x16x32_bf16 v[196:199], v[40:43], v[112:115], v[196:199]
    v_mfma_f32_16x16x32_bf16 v[200:203], v[44:47], v[112:115], v[200:203]
    ds_read_b64_tr_b16 v[62:63], v13 offset:16896
    v_mfma_f32_16x16x32_bf16 v[204:207], v[48:51], v[112:115], v[204:207]
    v_mfma_f32_16x16x32_bf16 v[208:211], v[36:39], v[116:119], v[208:211]
    ds_read_b64_tr_b16 v[64:65], v14 offset:16384
    v_mfma_f32_16x16x32_bf16 v[212:215], v[40:43], v[116:119], v[212:215]
    v_mfma_f32_16x16x32_bf16 v[216:219], v[44:47], v[116:119], v[216:219]
    ds_read_b64_tr_b16 v[66:67], v14 offset:16896
    v_mfma_f32_16x16x32_bf16 v[220:223], v[48:51], v[116:119], v[220:223]
    v_mfma_f32_16x16x32_bf16 v[224:227], v[36:39], v[120:123], v[224:227]
    v_mfma_f32_16x16x32_bf16 v[228:231], v[40:43], v[120:123], v[228:231]
    v_mfma_f32_16x16x32_bf16 v[232:235], v[44:47], v[120:123], v[232:235]
    ds_read_b128 v[92:95], v9 offset:23040
    v_mfma_f32_16x16x32_bf16 v[236:239], v[48:51], v[120:123], v[236:239]
    v_mfma_f32_16x16x32_bf16 v[240:243], v[36:39], v[124:127], v[240:243]
    v_mfma_f32_16x16x32_bf16 v[244:247], v[40:43], v[124:127], v[244:247]
    v_mfma_f32_16x16x32_bf16 v[248:251], v[44:47], v[124:127], v[248:251]
    v_mfma_f32_16x16x32_bf16 v[252:255], v[48:51], v[124:127], v[252:255]
    s_waitcnt lgkmcnt(7)
    v_mfma_f32_16x16x32_bf16 v[128:131], v[52:55], v[100:103], v[128:131]
    s_waitcnt lgkmcnt(1)
    s_add_u32 m0, s29, 16384
    s_add_u32 s32, s46, 9437184
    buffer_load_dwordx4 v15, s[12:15], s32 offen  lds
    v_mfma_f32_16x16x32_bf16 v[132:135], v[56:59], v[100:103], v[132:135]
    v_mfma_f32_16x16x32_bf16 v[136:139], v[60:63], v[100:103], v[136:139]
    buffer_load_dwordx4 v16, s[12:15], s32 offen offset:1024  lds
    v_mfma_f32_16x16x32_bf16 v[140:143], v[64:67], v[100:103], v[140:143]
    v_mfma_f32_16x16x32_bf16 v[144:147], v[52:55], v[104:107], v[144:147]
    buffer_load_dwordx4 v17, s[12:15], s32 offen offset:2048  lds
    v_mfma_f32_16x16x32_bf16 v[148:151], v[56:59], v[104:107], v[148:151]
    v_mfma_f32_16x16x32_bf16 v[152:155], v[60:63], v[104:107], v[152:155]
    buffer_load_dwordx4 v18, s[12:15], s32 offen offset:3072  lds
    v_mfma_f32_16x16x32_bf16 v[156:159], v[64:67], v[104:107], v[156:159]
    v_mfma_f32_16x16x32_bf16 v[160:163], v[52:55], v[108:111], v[160:163]
    s_waitcnt vmcnt(16)
    ds_read_b64_tr_b16 v[68:69], v11 offset:0
    v_mfma_f32_16x16x32_bf16 v[164:167], v[56:59], v[108:111], v[164:167]
    v_mfma_f32_16x16x32_bf16 v[168:171], v[60:63], v[108:111], v[168:171]
    ds_read_b64_tr_b16 v[70:71], v11 offset:512
    v_mfma_f32_16x16x32_bf16 v[172:175], v[64:67], v[108:111], v[172:175]
    v_mfma_f32_16x16x32_bf16 v[176:179], v[52:55], v[112:115], v[176:179]
    ds_read_b64_tr_b16 v[72:73], v12 offset:0
    v_mfma_f32_16x16x32_bf16 v[180:183], v[56:59], v[112:115], v[180:183]
    v_mfma_f32_16x16x32_bf16 v[184:187], v[60:63], v[112:115], v[184:187]
    ds_read_b64_tr_b16 v[74:75], v12 offset:512
    v_mfma_f32_16x16x32_bf16 v[188:191], v[64:67], v[112:115], v[188:191]
    v_mfma_f32_16x16x32_bf16 v[192:195], v[52:55], v[116:119], v[192:195]
    ds_read_b64_tr_b16 v[76:77], v13 offset:0
    v_mfma_f32_16x16x32_bf16 v[196:199], v[56:59], v[116:119], v[196:199]
    v_mfma_f32_16x16x32_bf16 v[200:203], v[60:63], v[116:119], v[200:203]
    ds_read_b64_tr_b16 v[78:79], v13 offset:512
    v_mfma_f32_16x16x32_bf16 v[204:207], v[64:67], v[116:119], v[204:207]
    v_mfma_f32_16x16x32_bf16 v[208:211], v[52:55], v[120:123], v[208:211]
    ds_read_b64_tr_b16 v[80:81], v14 offset:0
    v_mfma_f32_16x16x32_bf16 v[212:215], v[56:59], v[120:123], v[212:215]
    v_mfma_f32_16x16x32_bf16 v[216:219], v[60:63], v[120:123], v[216:219]
    ds_read_b64_tr_b16 v[82:83], v14 offset:512
    v_mfma_f32_16x16x32_bf16 v[220:223], v[64:67], v[120:123], v[220:223]
    v_mfma_f32_16x16x32_bf16 v[224:227], v[52:55], v[124:127], v[224:227]
    v_mfma_f32_16x16x32_bf16 v[228:231], v[56:59], v[124:127], v[228:231]
    v_mfma_f32_16x16x32_bf16 v[232:235], v[60:63], v[124:127], v[232:235]
    ds_read_b128 v[96:99], v9 offset:27648
    v_mfma_f32_16x16x32_bf16 v[236:239], v[64:67], v[124:127], v[236:239]
    v_mfma_f32_16x16x32_bf16 v[240:243], v[52:55], v[84:87], v[240:243]
    v_mfma_f32_16x16x32_bf16 v[244:247], v[56:59], v[84:87], v[244:247]
    v_mfma_f32_16x16x32_bf16 v[248:251], v[60:63], v[84:87], v[248:251]
    v_mfma_f32_16x16x32_bf16 v[252:255], v[64:67], v[84:87], v[252:255]
    s_waitcnt lgkmcnt(7)
    v_mfma_f32_16x16x32_bf16 v[128:131], v[68:71], v[104:107], v[128:131]
    s_waitcnt lgkmcnt(1)
    s_add_u32 m0, s29, 0
    s_add_u32 s32, s46, 10485760
    buffer_load_dwordx4 v15, s[12:15], s32 offen  lds
    v_mfma_f32_16x16x32_bf16 v[132:135], v[72:75], v[104:107], v[132:135]
    v_mfma_f32_16x16x32_bf16 v[136:139], v[76:79], v[104:107], v[136:139]
    buffer_load_dwordx4 v16, s[12:15], s32 offen offset:1024  lds
    v_mfma_f32_16x16x32_bf16 v[140:143], v[80:83], v[104:107], v[140:143]
    v_mfma_f32_16x16x32_bf16 v[144:147], v[68:71], v[108:111], v[144:147]
    buffer_load_dwordx4 v17, s[12:15], s32 offen offset:2048  lds
    v_mfma_f32_16x16x32_bf16 v[148:151], v[72:75], v[108:111], v[148:151]
    v_mfma_f32_16x16x32_bf16 v[152:155], v[76:79], v[108:111], v[152:155]
    buffer_load_dwordx4 v18, s[12:15], s32 offen offset:3072  lds
    v_mfma_f32_16x16x32_bf16 v[156:159], v[80:83], v[108:111], v[156:159]
    v_mfma_f32_16x16x32_bf16 v[160:163], v[68:71], v[112:115], v[160:163]
    s_waitcnt vmcnt(16)
    ds_read_b64_tr_b16 v[36:37], v11 offset:4096
    v_mfma_f32_16x16x32_bf16 v[164:167], v[72:75], v[112:115], v[164:167]
    v_mfma_f32_16x16x32_bf16 v[168:171], v[76:79], v[112:115], v[168:171]
    ds_read_b64_tr_b16 v[38:39], v11 offset:4608
    v_mfma_f32_16x16x32_bf16 v[172:175], v[80:83], v[112:115], v[172:175]
    v_mfma_f32_16x16x32_bf16 v[176:179], v[68:71], v[116:119], v[176:179]
    ds_read_b64_tr_b16 v[40:41], v12 offset:4096
    v_mfma_f32_16x16x32_bf16 v[180:183], v[72:75], v[116:119], v[180:183]
    v_mfma_f32_16x16x32_bf16 v[184:187], v[76:79], v[116:119], v[184:187]
    ds_read_b64_tr_b16 v[42:43], v12 offset:4608
    v_mfma_f32_16x16x32_bf16 v[188:191], v[80:83], v[116:119], v[188:191]
    v_mfma_f32_16x16x32_bf16 v[192:195], v[68:71], v[120:123], v[192:195]
    ds_read_b64_tr_b16 v[44:45], v13 offset:4096
    v_mfma_f32_16x16x32_bf16 v[196:199], v[72:75], v[120:123], v[196:199]
    v_mfma_f32_16x16x32_bf16 v[200:203], v[76:79], v[120:123], v[200:203]
    ds_read_b64_tr_b16 v[46:47], v13 offset:4608
    v_mfma_f32_16x16x32_bf16 v[204:207], v[80:83], v[120:123], v[204:207]
    v_mfma_f32_16x16x32_bf16 v[208:211], v[68:71], v[124:127], v[208:211]
    ds_read_b64_tr_b16 v[48:49], v14 offset:4096
    v_mfma_f32_16x16x32_bf16 v[212:215], v[72:75], v[124:127], v[212:215]
    v_mfma_f32_16x16x32_bf16 v[216:219], v[76:79], v[124:127], v[216:219]
    ds_read_b64_tr_b16 v[50:51], v14 offset:4608
    v_mfma_f32_16x16x32_bf16 v[220:223], v[80:83], v[124:127], v[220:223]
    v_mfma_f32_16x16x32_bf16 v[224:227], v[68:71], v[84:87], v[224:227]
    v_mfma_f32_16x16x32_bf16 v[228:231], v[72:75], v[84:87], v[228:231]
    v_mfma_f32_16x16x32_bf16 v[232:235], v[76:79], v[84:87], v[232:235]
    ds_read_b128 v[100:103], v9 offset:32256
    v_mfma_f32_16x16x32_bf16 v[236:239], v[80:83], v[84:87], v[236:239]
    v_mfma_f32_16x16x32_bf16 v[240:243], v[68:71], v[88:91], v[240:243]
    v_mfma_f32_16x16x32_bf16 v[244:247], v[72:75], v[88:91], v[244:247]
    v_mfma_f32_16x16x32_bf16 v[248:251], v[76:79], v[88:91], v[248:251]
    v_mfma_f32_16x16x32_bf16 v[252:255], v[80:83], v[88:91], v[252:255]
    s_waitcnt lgkmcnt(7)
    v_mfma_f32_16x16x32_bf16 v[128:131], v[36:39], v[108:111], v[128:131]
    s_waitcnt lgkmcnt(1)
    s_add_u32 m0, s29, 4096
    s_add_u32 s32, s46, 11534336
    buffer_load_dwordx4 v15, s[12:15], s32 offen  lds
    v_mfma_f32_16x16x32_bf16 v[132:135], v[40:43], v[108:111], v[132:135]
    v_mfma_f32_16x16x32_bf16 v[136:139], v[44:47], v[108:111], v[136:139]
    buffer_load_dwordx4 v16, s[12:15], s32 offen offset:1024  lds
    v_mfma_f32_16x16x32_bf16 v[140:143], v[48:51], v[108:111], v[140:143]
    v_mfma_f32_16x16x32_bf16 v[144:147], v[36:39], v[112:115], v[144:147]
    buffer_load_dwordx4 v17, s[12:15], s32 offen offset:2048  lds
    v_mfma_f32_16x16x32_bf16 v[148:151], v[40:43], v[112:115], v[148:151]
    v_mfma_f32_16x16x32_bf16 v[152:155], v[44:47], v[112:115], v[152:155]
    buffer_load_dwordx4 v18, s[12:15], s32 offen offset:3072  lds
    v_mfma_f32_16x16x32_bf16 v[156:159], v[48:51], v[112:115], v[156:159]
    v_mfma_f32_16x16x32_bf16 v[160:163], v[36:39], v[116:119], v[160:163]
    s_waitcnt vmcnt(16)
    ds_read_b64_tr_b16 v[52:53], v11 offset:8192
    v_mfma_f32_16x16x32_bf16 v[164:167], v[40:43], v[116:119], v[164:167]
    v_mfma_f32_16x16x32_bf16 v[168:171], v[44:47], v[116:119], v[168:171]
    ds_read_b64_tr_b16 v[54:55], v11 offset:8704
    v_mfma_f32_16x16x32_bf16 v[172:175], v[48:51], v[116:119], v[172:175]
    v_mfma_f32_16x16x32_bf16 v[176:179], v[36:39], v[120:123], v[176:179]
    ds_read_b64_tr_b16 v[56:57], v12 offset:8192
    v_mfma_f32_16x16x32_bf16 v[180:183], v[40:43], v[120:123], v[180:183]
    v_mfma_f32_16x16x32_bf16 v[184:187], v[44:47], v[120:123], v[184:187]
    ds_read_b64_tr_b16 v[58:59], v12 offset:8704
    v_mfma_f32_16x16x32_bf16 v[188:191], v[48:51], v[120:123], v[188:191]
    v_mfma_f32_16x16x32_bf16 v[192:195], v[36:39], v[124:127], v[192:195]
    ds_read_b64_tr_b16 v[60:61], v13 offset:8192
    v_mfma_f32_16x16x32_bf16 v[196:199], v[40:43], v[124:127], v[196:199]
    v_mfma_f32_16x16x32_bf16 v[200:203], v[44:47], v[124:127], v[200:203]
    ds_read_b64_tr_b16 v[62:63], v13 offset:8704
    v_mfma_f32_16x16x32_bf16 v[204:207], v[48:51], v[124:127], v[204:207]
    v_mfma_f32_16x16x32_bf16 v[208:211], v[36:39], v[84:87], v[208:211]
    ds_read_b64_tr_b16 v[64:65], v14 offset:8192
    v_mfma_f32_16x16x32_bf16 v[212:215], v[40:43], v[84:87], v[212:215]
    v_mfma_f32_16x16x32_bf16 v[216:219], v[44:47], v[84:87], v[216:219]
    ds_read_b64_tr_b16 v[66:67], v14 offset:8704
    v_mfma_f32_16x16x32_bf16 v[220:223], v[48:51], v[84:87], v[220:223]
    v_mfma_f32_16x16x32_bf16 v[224:227], v[36:39], v[88:91], v[224:227]
    v_mfma_f32_16x16x32_bf16 v[228:231], v[40:43], v[88:91], v[228:231]
    v_mfma_f32_16x16x32_bf16 v[232:235], v[44:47], v[88:91], v[232:235]
    ds_read_b128 v[104:107], v10 offset:0
    v_mfma_f32_16x16x32_bf16 v[236:239], v[48:51], v[88:91], v[236:239]
    v_mfma_f32_16x16x32_bf16 v[240:243], v[36:39], v[92:95], v[240:243]
    v_mfma_f32_16x16x32_bf16 v[244:247], v[40:43], v[92:95], v[244:247]
    v_mfma_f32_16x16x32_bf16 v[248:251], v[44:47], v[92:95], v[248:251]
    v_mfma_f32_16x16x32_bf16 v[252:255], v[48:51], v[92:95], v[252:255]
    s_waitcnt lgkmcnt(7)
    v_mfma_f32_16x16x32_bf16 v[128:131], v[52:55], v[112:115], v[128:131]
    s_waitcnt lgkmcnt(1)
    s_add_u32 m0, s29, 8192
    s_add_u32 s32, s46, 12582912
    buffer_load_dwordx4 v15, s[12:15], s32 offen  lds
    v_mfma_f32_16x16x32_bf16 v[132:135], v[56:59], v[112:115], v[132:135]
    v_mfma_f32_16x16x32_bf16 v[136:139], v[60:63], v[112:115], v[136:139]
    buffer_load_dwordx4 v16, s[12:15], s32 offen offset:1024  lds
    v_mfma_f32_16x16x32_bf16 v[140:143], v[64:67], v[112:115], v[140:143]
    v_mfma_f32_16x16x32_bf16 v[144:147], v[52:55], v[116:119], v[144:147]
    buffer_load_dwordx4 v17, s[12:15], s32 offen offset:2048  lds
    v_mfma_f32_16x16x32_bf16 v[148:151], v[56:59], v[116:119], v[148:151]
    v_mfma_f32_16x16x32_bf16 v[152:155], v[60:63], v[116:119], v[152:155]
    buffer_load_dwordx4 v18, s[12:15], s32 offen offset:3072  lds
    v_mfma_f32_16x16x32_bf16 v[156:159], v[64:67], v[116:119], v[156:159]
    v_mfma_f32_16x16x32_bf16 v[160:163], v[52:55], v[120:123], v[160:163]
    s_waitcnt vmcnt(16)
    ds_read_b64_tr_b16 v[68:69], v11 offset:12288
    v_mfma_f32_16x16x32_bf16 v[164:167], v[56:59], v[120:123], v[164:167]
    v_mfma_f32_16x16x32_bf16 v[168:171], v[60:63], v[120:123], v[168:171]
    ds_read_b64_tr_b16 v[70:71], v11 offset:12800
    v_mfma_f32_16x16x32_bf16 v[172:175], v[64:67], v[120:123], v[172:175]
    v_mfma_f32_16x16x32_bf16 v[176:179], v[52:55], v[124:127], v[176:179]
    ds_read_b64_tr_b16 v[72:73], v12 offset:12288
    v_mfma_f32_16x16x32_bf16 v[180:183], v[56:59], v[124:127], v[180:183]
    v_mfma_f32_16x16x32_bf16 v[184:187], v[60:63], v[124:127], v[184:187]
    ds_read_b64_tr_b16 v[74:75], v12 offset:12800
    v_mfma_f32_16x16x32_bf16 v[188:191], v[64:67], v[124:127], v[188:191]
    v_mfma_f32_16x16x32_bf16 v[192:195], v[52:55], v[84:87], v[192:195]
    ds_read_b64_tr_b16 v[76:77], v13 offset:12288
    v_mfma_f32_16x16x32_bf16 v[196:199], v[56:59], v[84:87], v[196:199]
    v_mfma_f32_16x16x32_bf16 v[200:203], v[60:63], v[84:87], v[200:203]
    ds_read_b64_tr_b16 v[78:79], v13 offset:12800
    v_mfma_f32_16x16x32_bf16 v[204:207], v[64:67], v[84:87], v[204:207]
    v_mfma_f32_16x16x32_bf16 v[208:211], v[52:55], v[88:91], v[208:211]
    ds_read_b64_tr_b16 v[80:81], v14 offset:12288
    v_mfma_f32_16x16x32_bf16 v[212:215], v[56:59], v[88:91], v[212:215]
    v_mfma_f32_16x16x32_bf16 v[216:219], v[60:63], v[88:91], v[216:219]
    ds_read_b64_tr_b16 v[82:83], v14 offset:12800
    v_mfma_f32_16x16x32_bf16 v[220:223], v[64:67], v[88:91], v[220:223]
    v_mfma_f32_16x16x32_bf16 v[224:227], v[52:55], v[92:95], v[224:227]
    v_mfma_f32_16x16x32_bf16 v[228:231], v[56:59], v[92:95], v[228:231]
    v_mfma_f32_16x16x32_bf16 v[232:235], v[60:63], v[92:95], v[232:235]
    ds_read_b128 v[108:111], v10 offset:4608
    v_mfma_f32_16x16x32_bf16 v[236:239], v[64:67], v[92:95], v[236:239]
    v_mfma_f32_16x16x32_bf16 v[240:243], v[52:55], v[96:99], v[240:243]
    v_mfma_f32_16x16x32_bf16 v[244:247], v[56:59], v[96:99], v[244:247]
    v_mfma_f32_16x16x32_bf16 v[248:251], v[60:63], v[96:99], v[248:251]
    v_mfma_f32_16x16x32_bf16 v[252:255], v[64:67], v[96:99], v[252:255]
    s_waitcnt lgkmcnt(7)
    v_mfma_f32_16x16x32_bf16 v[128:131], v[68:71], v[116:119], v[128:131]
    s_waitcnt lgkmcnt(1)
    s_add_u32 m0, s29, 12288
    s_add_u32 s32, s46, 13631488
    buffer_load_dwordx4 v15, s[12:15], s32 offen  lds
    v_mfma_f32_16x16x32_bf16 v[132:135], v[72:75], v[116:119], v[132:135]
    v_mfma_f32_16x16x32_bf16 v[136:139], v[76:79], v[116:119], v[136:139]
    buffer_load_dwordx4 v16, s[12:15], s32 offen offset:1024  lds
    v_mfma_f32_16x16x32_bf16 v[140:143], v[80:83], v[116:119], v[140:143]
    v_mfma_f32_16x16x32_bf16 v[144:147], v[68:71], v[120:123], v[144:147]
    buffer_load_dwordx4 v17, s[12:15], s32 offen offset:2048  lds
    v_mfma_f32_16x16x32_bf16 v[148:151], v[72:75], v[120:123], v[148:151]
    v_mfma_f32_16x16x32_bf16 v[152:155], v[76:79], v[120:123], v[152:155]
    buffer_load_dwordx4 v18, s[12:15], s32 offen offset:3072  lds
    v_mfma_f32_16x16x32_bf16 v[156:159], v[80:83], v[120:123], v[156:159]
    v_mfma_f32_16x16x32_bf16 v[160:163], v[68:71], v[124:127], v[160:163]
    s_waitcnt vmcnt(16)
    ds_read_b64_tr_b16 v[36:37], v11 offset:16384
    v_mfma_f32_16x16x32_bf16 v[164:167], v[72:75], v[124:127], v[164:167]
    v_mfma_f32_16x16x32_bf16 v[168:171], v[76:79], v[124:127], v[168:171]
    ds_read_b64_tr_b16 v[38:39], v11 offset:16896
    v_mfma_f32_16x16x32_bf16 v[172:175], v[80:83], v[124:127], v[172:175]
    v_mfma_f32_16x16x32_bf16 v[176:179], v[68:71], v[84:87], v[176:179]
    ds_read_b64_tr_b16 v[40:41], v12 offset:16384
    v_mfma_f32_16x16x32_bf16 v[180:183], v[72:75], v[84:87], v[180:183]
    v_mfma_f32_16x16x32_bf16 v[184:187], v[76:79], v[84:87], v[184:187]
    ds_read_b64_tr_b16 v[42:43], v12 offset:16896
    v_mfma_f32_16x16x32_bf16 v[188:191], v[80:83], v[84:87], v[188:191]
    v_mfma_f32_16x16x32_bf16 v[192:195], v[68:71], v[88:91], v[192:195]
    ds_read_b64_tr_b16 v[44:45], v13 offset:16384
    v_mfma_f32_16x16x32_bf16 v[196:199], v[72:75], v[88:91], v[196:199]
    v_mfma_f32_16x16x32_bf16 v[200:203], v[76:79], v[88:91], v[200:203]
    ds_read_b64_tr_b16 v[46:47], v13 offset:16896
    v_mfma_f32_16x16x32_bf16 v[204:207], v[80:83], v[88:91], v[204:207]
    v_mfma_f32_16x16x32_bf16 v[208:211], v[68:71], v[92:95], v[208:211]
    ds_read_b64_tr_b16 v[48:49], v14 offset:16384
    v_mfma_f32_16x16x32_bf16 v[212:215], v[72:75], v[92:95], v[212:215]
    v_mfma_f32_16x16x32_bf16 v[216:219], v[76:79], v[92:95], v[216:219]
    ds_read_b64_tr_b16 v[50:51], v14 offset:16896
    v_mfma_f32_16x16x32_bf16 v[220:223], v[80:83], v[92:95], v[220:223]
    v_mfma_f32_16x16x32_bf16 v[224:227], v[68:71], v[96:99], v[224:227]
    v_mfma_f32_16x16x32_bf16 v[228:231], v[72:75], v[96:99], v[228:231]
    v_mfma_f32_16x16x32_bf16 v[232:235], v[76:79], v[96:99], v[232:235]
    ds_read_b128 v[112:115], v10 offset:9216
    v_mfma_f32_16x16x32_bf16 v[236:239], v[80:83], v[96:99], v[236:239]
    v_mfma_f32_16x16x32_bf16 v[240:243], v[68:71], v[100:103], v[240:243]
    v_mfma_f32_16x16x32_bf16 v[244:247], v[72:75], v[100:103], v[244:247]
    v_mfma_f32_16x16x32_bf16 v[248:251], v[76:79], v[100:103], v[248:251]
    v_mfma_f32_16x16x32_bf16 v[252:255], v[80:83], v[100:103], v[252:255]
    s_waitcnt lgkmcnt(7)
    v_mfma_f32_16x16x32_bf16 v[128:131], v[36:39], v[120:123], v[128:131]
    s_waitcnt lgkmcnt(1)
    s_add_u32 m0, s29, 16384
    s_add_u32 s32, s46, 14680064
    buffer_load_dwordx4 v15, s[12:15], s32 offen  lds
    v_mfma_f32_16x16x32_bf16 v[132:135], v[40:43], v[120:123], v[132:135]
    v_mfma_f32_16x16x32_bf16 v[136:139], v[44:47], v[120:123], v[136:139]
    buffer_load_dwordx4 v16, s[12:15], s32 offen offset:1024  lds
    v_mfma_f32_16x16x32_bf16 v[140:143], v[48:51], v[120:123], v[140:143]
    v_mfma_f32_16x16x32_bf16 v[144:147], v[36:39], v[124:127], v[144:147]
    buffer_load_dwordx4 v17, s[12:15], s32 offen offset:2048  lds
    v_mfma_f32_16x16x32_bf16 v[148:151], v[40:43], v[124:127], v[148:151]
    v_mfma_f32_16x16x32_bf16 v[152:155], v[44:47], v[124:127], v[152:155]
    buffer_load_dwordx4 v18, s[12:15], s32 offen offset:3072  lds
    v_mfma_f32_16x16x32_bf16 v[156:159], v[48:51], v[124:127], v[156:159]
    v_mfma_f32_16x16x32_bf16 v[160:163], v[36:39], v[84:87], v[160:163]
    s_waitcnt vmcnt(16)
    ds_read_b64_tr_b16 v[52:53], v11 offset:0
    v_mfma_f32_16x16x32_bf16 v[164:167], v[40:43], v[84:87], v[164:167]
    v_mfma_f32_16x16x32_bf16 v[168:171], v[44:47], v[84:87], v[168:171]
    ds_read_b64_tr_b16 v[54:55], v11 offset:512
    v_mfma_f32_16x16x32_bf16 v[172:175], v[48:51], v[84:87], v[172:175]
    v_mfma_f32_16x16x32_bf16 v[176:179], v[36:39], v[88:91], v[176:179]
    ds_read_b64_tr_b16 v[56:57], v12 offset:0
    v_mfma_f32_16x16x32_bf16 v[180:183], v[40:43], v[88:91], v[180:183]
    v_mfma_f32_16x16x32_bf16 v[184:187], v[44:47], v[88:91], v[184:187]
    ds_read_b64_tr_b16 v[58:59], v12 offset:512
    v_mfma_f32_16x16x32_bf16 v[188:191], v[48:51], v[88:91], v[188:191]
    v_mfma_f32_16x16x32_bf16 v[192:195], v[36:39], v[92:95], v[192:195]
    ds_read_b64_tr_b16 v[60:61], v13 offset:0
    v_mfma_f32_16x16x32_bf16 v[196:199], v[40:43], v[92:95], v[196:199]
    v_mfma_f32_16x16x32_bf16 v[200:203], v[44:47], v[92:95], v[200:203]
    ds_read_b64_tr_b16 v[62:63], v13 offset:512
    v_mfma_f32_16x16x32_bf16 v[204:207], v[48:51], v[92:95], v[204:207]
    v_mfma_f32_16x16x32_bf16 v[208:211], v[36:39], v[96:99], v[208:211]
    ds_read_b64_tr_b16 v[64:65], v14 offset:0
    v_mfma_f32_16x16x32_bf16 v[212:215], v[40:43], v[96:99], v[212:215]
    v_mfma_f32_16x16x32_bf16 v[216:219], v[44:47], v[96:99], v[216:219]
    ds_read_b64_tr_b16 v[66:67], v14 offset:512
    v_mfma_f32_16x16x32_bf16 v[220:223], v[48:51], v[96:99], v[220:223]
    v_mfma_f32_16x16x32_bf16 v[224:227], v[36:39], v[100:103], v[224:227]
    v_mfma_f32_16x16x32_bf16 v[228:231], v[40:43], v[100:103], v[228:231]
    v_mfma_f32_16x16x32_bf16 v[232:235], v[44:47], v[100:103], v[232:235]
    ds_read_b128 v[116:119], v10 offset:13824
    v_mfma_f32_16x16x32_bf16 v[236:239], v[48:51], v[100:103], v[236:239]
    v_mfma_f32_16x16x32_bf16 v[240:243], v[36:39], v[104:107], v[240:243]
    v_mfma_f32_16x16x32_bf16 v[244:247], v[40:43], v[104:107], v[244:247]
    v_mfma_f32_16x16x32_bf16 v[248:251], v[44:47], v[104:107], v[248:251]
    v_mfma_f32_16x16x32_bf16 v[252:255], v[48:51], v[104:107], v[252:255]
    s_waitcnt lgkmcnt(7)
    v_mfma_f32_16x16x32_bf16 v[128:131], v[52:55], v[124:127], v[128:131]
    s_waitcnt lgkmcnt(1)
    s_add_u32 m0, s29, 0
    s_add_u32 s32, s47, 0
    buffer_load_dwordx4 v15, s[12:15], s32 offen  lds
    v_mfma_f32_16x16x32_bf16 v[132:135], v[56:59], v[124:127], v[132:135]
    v_mfma_f32_16x16x32_bf16 v[136:139], v[60:63], v[124:127], v[136:139]
    buffer_load_dwordx4 v16, s[12:15], s32 offen offset:1024  lds
    v_mfma_f32_16x16x32_bf16 v[140:143], v[64:67], v[124:127], v[140:143]
    v_mfma_f32_16x16x32_bf16 v[144:147], v[52:55], v[84:87], v[144:147]
    buffer_load_dwordx4 v17, s[12:15], s32 offen offset:2048  lds
    v_mfma_f32_16x16x32_bf16 v[148:151], v[56:59], v[84:87], v[148:151]
    v_mfma_f32_16x16x32_bf16 v[152:155], v[60:63], v[84:87], v[152:155]
    buffer_load_dwordx4 v18, s[12:15], s32 offen offset:3072  lds
    v_mfma_f32_16x16x32_bf16 v[156:159], v[64:67], v[84:87], v[156:159]
    v_mfma_f32_16x16x32_bf16 v[160:163], v[52:55], v[88:91], v[160:163]
    s_waitcnt vmcnt(16)
    ds_read_b64_tr_b16 v[68:69], v11 offset:4096
    v_mfma_f32_16x16x32_bf16 v[164:167], v[56:59], v[88:91], v[164:167]
    v_mfma_f32_16x16x32_bf16 v[168:171], v[60:63], v[88:91], v[168:171]
    ds_read_b64_tr_b16 v[70:71], v11 offset:4608
    v_mfma_f32_16x16x32_bf16 v[172:175], v[64:67], v[88:91], v[172:175]
    v_mfma_f32_16x16x32_bf16 v[176:179], v[52:55], v[92:95], v[176:179]
    ds_read_b64_tr_b16 v[72:73], v12 offset:4096
    v_mfma_f32_16x16x32_bf16 v[180:183], v[56:59], v[92:95], v[180:183]
    v_mfma_f32_16x16x32_bf16 v[184:187], v[60:63], v[92:95], v[184:187]
    ds_read_b64_tr_b16 v[74:75], v12 offset:4608
    v_mfma_f32_16x16x32_bf16 v[188:191], v[64:67], v[92:95], v[188:191]
    v_mfma_f32_16x16x32_bf16 v[192:195], v[52:55], v[96:99], v[192:195]
    ds_read_b64_tr_b16 v[76:77], v13 offset:4096
    v_mfma_f32_16x16x32_bf16 v[196:199], v[56:59], v[96:99], v[196:199]
    v_mfma_f32_16x16x32_bf16 v[200:203], v[60:63], v[96:99], v[200:203]
    ds_read_b64_tr_b16 v[78:79], v13 offset:4608
    v_mfma_f32_16x16x32_bf16 v[204:207], v[64:67], v[96:99], v[204:207]
    v_mfma_f32_16x16x32_bf16 v[208:211], v[52:55], v[100:103], v[208:211]
    ds_read_b64_tr_b16 v[80:81], v14 offset:4096
    v_mfma_f32_16x16x32_bf16 v[212:215], v[56:59], v[100:103], v[212:215]
    v_mfma_f32_16x16x32_bf16 v[216:219], v[60:63], v[100:103], v[216:219]
    ds_read_b64_tr_b16 v[82:83], v14 offset:4608
    v_mfma_f32_16x16x32_bf16 v[220:223], v[64:67], v[100:103], v[220:223]
    v_mfma_f32_16x16x32_bf16 v[224:227], v[52:55], v[104:107], v[224:227]
    v_mfma_f32_16x16x32_bf16 v[228:231], v[56:59], v[104:107], v[228:231]
    v_mfma_f32_16x16x32_bf16 v[232:235], v[60:63], v[104:107], v[232:235]
    ds_read_b128 v[120:123], v10 offset:18432
    v_mfma_f32_16x16x32_bf16 v[236:239], v[64:67], v[104:107], v[236:239]
    v_mfma_f32_16x16x32_bf16 v[240:243], v[52:55], v[108:111], v[240:243]
    v_mfma_f32_16x16x32_bf16 v[244:247], v[56:59], v[108:111], v[244:247]
    v_mfma_f32_16x16x32_bf16 v[248:251], v[60:63], v[108:111], v[248:251]
    v_mfma_f32_16x16x32_bf16 v[252:255], v[64:67], v[108:111], v[252:255]
    s_waitcnt lgkmcnt(7)
    v_mfma_f32_16x16x32_bf16 v[128:131], v[68:71], v[84:87], v[128:131]
    s_waitcnt lgkmcnt(1)
    s_add_u32 m0, s29, 4096
    s_add_u32 s32, s47, 1048576
    buffer_load_dwordx4 v15, s[12:15], s32 offen  lds
    v_mfma_f32_16x16x32_bf16 v[132:135], v[72:75], v[84:87], v[132:135]
    v_mfma_f32_16x16x32_bf16 v[136:139], v[76:79], v[84:87], v[136:139]
    buffer_load_dwordx4 v16, s[12:15], s32 offen offset:1024  lds
    v_mfma_f32_16x16x32_bf16 v[140:143], v[80:83], v[84:87], v[140:143]
    v_mfma_f32_16x16x32_bf16 v[144:147], v[68:71], v[88:91], v[144:147]
    buffer_load_dwordx4 v17, s[12:15], s32 offen offset:2048  lds
    v_mfma_f32_16x16x32_bf16 v[148:151], v[72:75], v[88:91], v[148:151]
    v_mfma_f32_16x16x32_bf16 v[152:155], v[76:79], v[88:91], v[152:155]
    buffer_load_dwordx4 v18, s[12:15], s32 offen offset:3072  lds
    v_mfma_f32_16x16x32_bf16 v[156:159], v[80:83], v[88:91], v[156:159]
    v_mfma_f32_16x16x32_bf16 v[160:163], v[68:71], v[92:95], v[160:163]
    s_waitcnt vmcnt(16)
    ds_read_b64_tr_b16 v[36:37], v11 offset:8192
    v_mfma_f32_16x16x32_bf16 v[164:167], v[72:75], v[92:95], v[164:167]
    v_mfma_f32_16x16x32_bf16 v[168:171], v[76:79], v[92:95], v[168:171]
    ds_read_b64_tr_b16 v[38:39], v11 offset:8704
    v_mfma_f32_16x16x32_bf16 v[172:175], v[80:83], v[92:95], v[172:175]
    v_mfma_f32_16x16x32_bf16 v[176:179], v[68:71], v[96:99], v[176:179]
    ds_read_b64_tr_b16 v[40:41], v12 offset:8192
    v_mfma_f32_16x16x32_bf16 v[180:183], v[72:75], v[96:99], v[180:183]
    v_mfma_f32_16x16x32_bf16 v[184:187], v[76:79], v[96:99], v[184:187]
    ds_read_b64_tr_b16 v[42:43], v12 offset:8704
    v_mfma_f32_16x16x32_bf16 v[188:191], v[80:83], v[96:99], v[188:191]
    v_mfma_f32_16x16x32_bf16 v[192:195], v[68:71], v[100:103], v[192:195]
    ds_read_b64_tr_b16 v[44:45], v13 offset:8192
    v_mfma_f32_16x16x32_bf16 v[196:199], v[72:75], v[100:103], v[196:199]
    v_mfma_f32_16x16x32_bf16 v[200:203], v[76:79], v[100:103], v[200:203]
    ds_read_b64_tr_b16 v[46:47], v13 offset:8704
    v_mfma_f32_16x16x32_bf16 v[204:207], v[80:83], v[100:103], v[204:207]
    v_mfma_f32_16x16x32_bf16 v[208:211], v[68:71], v[104:107], v[208:211]
    ds_read_b64_tr_b16 v[48:49], v14 offset:8192
    v_mfma_f32_16x16x32_bf16 v[212:215], v[72:75], v[104:107], v[212:215]
    v_mfma_f32_16x16x32_bf16 v[216:219], v[76:79], v[104:107], v[216:219]
    ds_read_b64_tr_b16 v[50:51], v14 offset:8704
    v_mfma_f32_16x16x32_bf16 v[220:223], v[80:83], v[104:107], v[220:223]
    v_mfma_f32_16x16x32_bf16 v[224:227], v[68:71], v[108:111], v[224:227]
    v_mfma_f32_16x16x32_bf16 v[228:231], v[72:75], v[108:111], v[228:231]
    v_mfma_f32_16x16x32_bf16 v[232:235], v[76:79], v[108:111], v[232:235]
    ds_read_b128 v[124:127], v10 offset:23040
    v_mfma_f32_16x16x32_bf16 v[236:239], v[80:83], v[108:111], v[236:239]
    v_mfma_f32_16x16x32_bf16 v[240:243], v[68:71], v[112:115], v[240:243]
    v_mfma_f32_16x16x32_bf16 v[244:247], v[72:75], v[112:115], v[244:247]
    v_mfma_f32_16x16x32_bf16 v[248:251], v[76:79], v[112:115], v[248:251]
    v_mfma_f32_16x16x32_bf16 v[252:255], v[80:83], v[112:115], v[252:255]
    s_waitcnt lgkmcnt(7)
    v_mfma_f32_16x16x32_bf16 v[128:131], v[36:39], v[88:91], v[128:131]
    s_waitcnt lgkmcnt(1)
    s_add_u32 m0, s29, 8192
    s_add_u32 s32, s47, 2097152
    buffer_load_dwordx4 v15, s[12:15], s32 offen  lds
    v_mfma_f32_16x16x32_bf16 v[132:135], v[40:43], v[88:91], v[132:135]
    v_mfma_f32_16x16x32_bf16 v[136:139], v[44:47], v[88:91], v[136:139]
    buffer_load_dwordx4 v16, s[12:15], s32 offen offset:1024  lds
    v_mfma_f32_16x16x32_bf16 v[140:143], v[48:51], v[88:91], v[140:143]
    v_mfma_f32_16x16x32_bf16 v[144:147], v[36:39], v[92:95], v[144:147]
    buffer_load_dwordx4 v17, s[12:15], s32 offen offset:2048  lds
    v_mfma_f32_16x16x32_bf16 v[148:151], v[40:43], v[92:95], v[148:151]
    v_mfma_f32_16x16x32_bf16 v[152:155], v[44:47], v[92:95], v[152:155]
    buffer_load_dwordx4 v18, s[12:15], s32 offen offset:3072  lds
    v_mfma_f32_16x16x32_bf16 v[156:159], v[48:51], v[92:95], v[156:159]
    v_mfma_f32_16x16x32_bf16 v[160:163], v[36:39], v[96:99], v[160:163]
    s_waitcnt vmcnt(16)
    ds_read_b64_tr_b16 v[52:53], v11 offset:12288
    v_mfma_f32_16x16x32_bf16 v[164:167], v[40:43], v[96:99], v[164:167]
    v_mfma_f32_16x16x32_bf16 v[168:171], v[44:47], v[96:99], v[168:171]
    ds_read_b64_tr_b16 v[54:55], v11 offset:12800
    v_mfma_f32_16x16x32_bf16 v[172:175], v[48:51], v[96:99], v[172:175]
    v_mfma_f32_16x16x32_bf16 v[176:179], v[36:39], v[100:103], v[176:179]
    ds_read_b64_tr_b16 v[56:57], v12 offset:12288
    v_mfma_f32_16x16x32_bf16 v[180:183], v[40:43], v[100:103], v[180:183]
    v_mfma_f32_16x16x32_bf16 v[184:187], v[44:47], v[100:103], v[184:187]
    ds_read_b64_tr_b16 v[58:59], v12 offset:12800
    v_mfma_f32_16x16x32_bf16 v[188:191], v[48:51], v[100:103], v[188:191]
    v_mfma_f32_16x16x32_bf16 v[192:195], v[36:39], v[104:107], v[192:195]
    ds_read_b64_tr_b16 v[60:61], v13 offset:12288
    v_mfma_f32_16x16x32_bf16 v[196:199], v[40:43], v[104:107], v[196:199]
    v_mfma_f32_16x16x32_bf16 v[200:203], v[44:47], v[104:107], v[200:203]
    ds_read_b64_tr_b16 v[62:63], v13 offset:12800
    v_mfma_f32_16x16x32_bf16 v[204:207], v[48:51], v[104:107], v[204:207]
    v_mfma_f32_16x16x32_bf16 v[208:211], v[36:39], v[108:111], v[208:211]
    ds_read_b64_tr_b16 v[64:65], v14 offset:12288
    s_waitcnt lgkmcnt(7)
    s_barrier
    v_mfma_f32_16x16x32_bf16 v[212:215], v[40:43], v[108:111], v[212:215]
    v_mfma_f32_16x16x32_bf16 v[216:219], v[44:47], v[108:111], v[216:219]
    ds_read_b64_tr_b16 v[66:67], v14 offset:12800
    ds_read_b128 v[84:87], v28 offset:0
    v_mfma_f32_16x16x32_bf16 v[220:223], v[48:51], v[108:111], v[220:223]
    v_mfma_f32_16x16x32_bf16 v[224:227], v[36:39], v[112:115], v[224:227]
    v_mfma_f32_16x16x32_bf16 v[228:231], v[40:43], v[112:115], v[228:231]
    v_mfma_f32_16x16x32_bf16 v[232:235], v[44:47], v[112:115], v[232:235]
    v_mfma_f32_16x16x32_bf16 v[236:239], v[48:51], v[112:115], v[236:239]
    v_mfma_f32_16x16x32_bf16 v[240:243], v[36:39], v[116:119], v[240:243]
    v_mfma_f32_16x16x32_bf16 v[244:247], v[40:43], v[116:119], v[244:247]
    v_mfma_f32_16x16x32_bf16 v[248:251], v[44:47], v[116:119], v[248:251]
    v_mfma_f32_16x16x32_bf16 v[252:255], v[48:51], v[116:119], v[252:255]
    s_waitcnt lgkmcnt(7)
    v_mfma_f32_16x16x32_bf16 v[128:131], v[52:55], v[92:95], v[128:131]
    s_waitcnt lgkmcnt(1)
    s_add_u32 m0, s29, 12288
    s_add_u32 s32, s47, 3145728
    buffer_load_dwordx4 v15, s[12:15], s32 offen  lds
    v_mfma_f32_16x16x32_bf16 v[132:135], v[56:59], v[92:95], v[132:135]
    v_mfma_f32_16x16x32_bf16 v[136:139], v[60:63], v[92:95], v[136:139]
    buffer_load_dwordx4 v16, s[12:15], s32 offen offset:1024  lds
    v_mfma_f32_16x16x32_bf16 v[140:143], v[64:67], v[92:95], v[140:143]
    v_mfma_f32_16x16x32_bf16 v[144:147], v[52:55], v[96:99], v[144:147]
    buffer_load_dwordx4 v17, s[12:15], s32 offen offset:2048  lds
    v_mfma_f32_16x16x32_bf16 v[148:151], v[56:59], v[96:99], v[148:151]
    ds_read_b128 v[88:91], v28 offset:4608
    v_mfma_f32_16x16x32_bf16 v[152:155], v[60:63], v[96:99], v[152:155]
    buffer_load_dwordx4 v18, s[12:15], s32 offen offset:3072  lds
    v_mfma_f32_16x16x32_bf16 v[156:159], v[64:67], v[96:99], v[156:159]
    v_mfma_f32_16x16x32_bf16 v[160:163], v[52:55], v[100:103], v[160:163]
    s_waitcnt vmcnt(16)
    ds_read_b64_tr_b16 v[68:69], v11 offset:16384
    v_mfma_f32_16x16x32_bf16 v[164:167], v[56:59], v[100:103], v[164:167]
    v_mfma_f32_16x16x32_bf16 v[168:171], v[60:63], v[100:103], v[168:171]
    ds_read_b64_tr_b16 v[70:71], v11 offset:16896
    v_mfma_f32_16x16x32_bf16 v[172:175], v[64:67], v[100:103], v[172:175]
    v_mfma_f32_16x16x32_bf16 v[176:179], v[52:55], v[104:107], v[176:179]
    ds_read_b64_tr_b16 v[72:73], v12 offset:16384
    v_mfma_f32_16x16x32_bf16 v[180:183], v[56:59], v[104:107], v[180:183]
    v_mfma_f32_16x16x32_bf16 v[184:187], v[60:63], v[104:107], v[184:187]
    ds_read_b64_tr_b16 v[74:75], v12 offset:16896
    v_mfma_f32_16x16x32_bf16 v[188:191], v[64:67], v[104:107], v[188:191]
    v_mfma_f32_16x16x32_bf16 v[192:195], v[52:55], v[108:111], v[192:195]
    ds_read_b64_tr_b16 v[76:77], v13 offset:16384
    v_mfma_f32_16x16x32_bf16 v[196:199], v[56:59], v[108:111], v[196:199]
    v_mfma_f32_16x16x32_bf16 v[200:203], v[60:63], v[108:111], v[200:203]
    ds_read_b64_tr_b16 v[78:79], v13 offset:16896
    v_mfma_f32_16x16x32_bf16 v[204:207], v[64:67], v[108:111], v[204:207]
    v_mfma_f32_16x16x32_bf16 v[208:211], v[52:55], v[112:115], v[208:211]
    ds_read_b64_tr_b16 v[80:81], v14 offset:16384
    v_mfma_f32_16x16x32_bf16 v[212:215], v[56:59], v[112:115], v[212:215]
    v_mfma_f32_16x16x32_bf16 v[216:219], v[60:63], v[112:115], v[216:219]
    ds_read_b64_tr_b16 v[82:83], v14 offset:16896
    v_mfma_f32_16x16x32_bf16 v[220:223], v[64:67], v[112:115], v[220:223]
    v_mfma_f32_16x16x32_bf16 v[224:227], v[52:55], v[116:119], v[224:227]
    ds_read_b128 v[92:95], v28 offset:9216
    v_mfma_f32_16x16x32_bf16 v[228:231], v[56:59], v[116:119], v[228:231]
    v_mfma_f32_16x16x32_bf16 v[232:235], v[60:63], v[116:119], v[232:235]
    v_mfma_f32_16x16x32_bf16 v[236:239], v[64:67], v[116:119], v[236:239]
    v_mfma_f32_16x16x32_bf16 v[240:243], v[52:55], v[120:123], v[240:243]
    v_mfma_f32_16x16x32_bf16 v[244:247], v[56:59], v[120:123], v[244:247]
    v_mfma_f32_16x16x32_bf16 v[248:251], v[60:63], v[120:123], v[248:251]
    v_mfma_f32_16x16x32_bf16 v[252:255], v[64:67], v[120:123], v[252:255]
    s_waitcnt lgkmcnt(7)
    v_mfma_f32_16x16x32_bf16 v[128:131], v[68:71], v[96:99], v[128:131]
    s_waitcnt lgkmcnt(1)
    s_add_u32 m0, s29, 16384
    s_add_u32 s32, s47, 4194304
    buffer_load_dwordx4 v15, s[12:15], s32 offen  lds
    v_mfma_f32_16x16x32_bf16 v[132:135], v[72:75], v[96:99], v[132:135]
    v_mfma_f32_16x16x32_bf16 v[136:139], v[76:79], v[96:99], v[136:139]
    buffer_load_dwordx4 v16, s[12:15], s32 offen offset:1024  lds
    v_mfma_f32_16x16x32_bf16 v[140:143], v[80:83], v[96:99], v[140:143]
    ds_read_b128 v[96:99], v28 offset:13824
    v_mfma_f32_16x16x32_bf16 v[144:147], v[68:71], v[100:103], v[144:147]
    buffer_load_dwordx4 v17, s[12:15], s32 offen offset:2048  lds
    v_mfma_f32_16x16x32_bf16 v[148:151], v[72:75], v[100:103], v[148:151]
    v_mfma_f32_16x16x32_bf16 v[152:155], v[76:79], v[100:103], v[152:155]
    buffer_load_dwordx4 v18, s[12:15], s32 offen offset:3072  lds
    v_mfma_f32_16x16x32_bf16 v[156:159], v[80:83], v[100:103], v[156:159]
    ds_read_b128 v[100:103], v28 offset:18432
    v_mfma_f32_16x16x32_bf16 v[160:163], v[68:71], v[104:107], v[160:163]
    s_waitcnt vmcnt(16)
    ds_read_b64_tr_b16 v[36:37], v11 offset:0
    v_mfma_f32_16x16x32_bf16 v[164:167], v[72:75], v[104:107], v[164:167]
    v_mfma_f32_16x16x32_bf16 v[168:171], v[76:79], v[104:107], v[168:171]
    ds_read_b64_tr_b16 v[38:39], v11 offset:512
    v_mfma_f32_16x16x32_bf16 v[172:175], v[80:83], v[104:107], v[172:175]
    ds_read_b128 v[104:107], v28 offset:23040
    v_mfma_f32_16x16x32_bf16 v[176:179], v[68:71], v[108:111], v[176:179]
    ds_read_b64_tr_b16 v[40:41], v12 offset:0
    v_mfma_f32_16x16x32_bf16 v[180:183], v[72:75], v[108:111], v[180:183]
    v_mfma_f32_16x16x32_bf16 v[184:187], v[76:79], v[108:111], v[184:187]
    ds_read_b64_tr_b16 v[42:43], v12 offset:512
    v_mfma_f32_16x16x32_bf16 v[188:191], v[80:83], v[108:111], v[188:191]
    ds_read_b128 v[108:111], v28 offset:27648
    v_mfma_f32_16x16x32_bf16 v[192:195], v[68:71], v[112:115], v[192:195]
    ds_read_b64_tr_b16 v[44:45], v13 offset:0
    v_mfma_f32_16x16x32_bf16 v[196:199], v[72:75], v[112:115], v[196:199]
    v_mfma_f32_16x16x32_bf16 v[200:203], v[76:79], v[112:115], v[200:203]
    ds_read_b64_tr_b16 v[46:47], v13 offset:512
    v_mfma_f32_16x16x32_bf16 v[204:207], v[80:83], v[112:115], v[204:207]
    ds_read_b128 v[112:115], v28 offset:32256
    v_mfma_f32_16x16x32_bf16 v[208:211], v[68:71], v[116:119], v[208:211]
    ds_read_b64_tr_b16 v[48:49], v14 offset:0
    v_mfma_f32_16x16x32_bf16 v[212:215], v[72:75], v[116:119], v[212:215]
    v_mfma_f32_16x16x32_bf16 v[216:219], v[76:79], v[116:119], v[216:219]
    ds_read_b64_tr_b16 v[50:51], v14 offset:512
    v_mfma_f32_16x16x32_bf16 v[220:223], v[80:83], v[116:119], v[220:223]
    ds_read_b128 v[116:119], v29 offset:0
    v_mfma_f32_16x16x32_bf16 v[224:227], v[68:71], v[120:123], v[224:227]
    v_mfma_f32_16x16x32_bf16 v[228:231], v[72:75], v[120:123], v[228:231]
    v_mfma_f32_16x16x32_bf16 v[232:235], v[76:79], v[120:123], v[232:235]
    v_mfma_f32_16x16x32_bf16 v[236:239], v[80:83], v[120:123], v[236:239]
    ds_read_b128 v[120:123], v29 offset:4608
    v_mfma_f32_16x16x32_bf16 v[240:243], v[68:71], v[124:127], v[240:243]
    v_mfma_f32_16x16x32_bf16 v[244:247], v[72:75], v[124:127], v[244:247]
    v_mfma_f32_16x16x32_bf16 v[248:251], v[76:79], v[124:127], v[248:251]
    v_mfma_f32_16x16x32_bf16 v[252:255], v[80:83], v[124:127], v[252:255]
    s_waitcnt lgkmcnt(11)
    v_mfma_f32_16x16x32_bf16 v[128:131], v[36:39], v[84:87], v[128:131]
    s_waitcnt lgkmcnt(2)
    s_add_u32 m0, s29, 0
    s_add_u32 s32, s47, 5242880
    buffer_load_dwordx4 v15, s[12:15], s32 offen  lds
    v_mfma_f32_16x16x32_bf16 v[132:135], v[40:43], v[84:87], v[132:135]
    v_mfma_f32_16x16x32_bf16 v[136:139], v[44:47], v[84:87], v[136:139]
    buffer_load_dwordx4 v16, s[12:15], s32 offen offset:1024  lds
    v_mfma_f32_16x16x32_bf16 v[140:143], v[48:51], v[84:87], v[140:143]
    v_mfma_f32_16x16x32_bf16 v[144:147], v[36:39], v[88:91], v[144:147]
    buffer_load_dwordx4 v17, s[12:15], s32 offen offset:2048  lds
    v_mfma_f32_16x16x32_bf16 v[148:151], v[40:43], v[88:91], v[148:151]
    v_mfma_f32_16x16x32_bf16 v[152:155], v[44:47], v[88:91], v[152:155]
    buffer_load_dwordx4 v18, s[12:15], s32 offen offset:3072  lds
    v_mfma_f32_16x16x32_bf16 v[156:159], v[48:51], v[88:91], v[156:159]
    v_mfma_f32_16x16x32_bf16 v[160:163], v[36:39], v[92:95], v[160:163]
    s_waitcnt vmcnt(16)
    ds_read_b64_tr_b16 v[52:53], v11 offset:4096
    v_mfma_f32_16x16x32_bf16 v[164:167], v[40:43], v[92:95], v[164:167]
    v_mfma_f32_16x16x32_bf16 v[168:171], v[44:47], v[92:95], v[168:171]
    ds_read_b64_tr_b16 v[54:55], v11 offset:4608
    v_mfma_f32_16x16x32_bf16 v[172:175], v[48:51], v[92:95], v[172:175]
    v_mfma_f32_16x16x32_bf16 v[176:179], v[36:39], v[96:99], v[176:179]
    ds_read_b64_tr_b16 v[56:57], v12 offset:4096
    v_mfma_f32_16x16x32_bf16 v[180:183], v[40:43], v[96:99], v[180:183]
    v_mfma_f32_16x16x32_bf16 v[184:187], v[44:47], v[96:99], v[184:187]
    ds_read_b64_tr_b16 v[58:59], v12 offset:4608
    v_mfma_f32_16x16x32_bf16 v[188:191], v[48:51], v[96:99], v[188:191]
    v_mfma_f32_16x16x32_bf16 v[192:195], v[36:39], v[100:103], v[192:195]
    ds_read_b64_tr_b16 v[60:61], v13 offset:4096
    v_mfma_f32_16x16x32_bf16 v[196:199], v[40:43], v[100:103], v[196:199]
    v_mfma_f32_16x16x32_bf16 v[200:203], v[44:47], v[100:103], v[200:203]
    ds_read_b64_tr_b16 v[62:63], v13 offset:4608
    v_mfma_f32_16x16x32_bf16 v[204:207], v[48:51], v[100:103], v[204:207]
    v_mfma_f32_16x16x32_bf16 v[208:211], v[36:39], v[104:107], v[208:211]
    ds_read_b64_tr_b16 v[64:65], v14 offset:4096
    v_mfma_f32_16x16x32_bf16 v[212:215], v[40:43], v[104:107], v[212:215]
    v_mfma_f32_16x16x32_bf16 v[216:219], v[44:47], v[104:107], v[216:219]
    ds_read_b64_tr_b16 v[66:67], v14 offset:4608
    v_mfma_f32_16x16x32_bf16 v[220:223], v[48:51], v[104:107], v[220:223]
    v_mfma_f32_16x16x32_bf16 v[224:227], v[36:39], v[108:111], v[224:227]
    v_mfma_f32_16x16x32_bf16 v[228:231], v[40:43], v[108:111], v[228:231]
    v_mfma_f32_16x16x32_bf16 v[232:235], v[44:47], v[108:111], v[232:235]
    ds_read_b128 v[124:127], v29 offset:9216
    v_mfma_f32_16x16x32_bf16 v[236:239], v[48:51], v[108:111], v[236:239]
    v_mfma_f32_16x16x32_bf16 v[240:243], v[36:39], v[112:115], v[240:243]
    v_mfma_f32_16x16x32_bf16 v[244:247], v[40:43], v[112:115], v[244:247]
    v_mfma_f32_16x16x32_bf16 v[248:251], v[44:47], v[112:115], v[248:251]
    v_mfma_f32_16x16x32_bf16 v[252:255], v[48:51], v[112:115], v[252:255]
    s_waitcnt lgkmcnt(7)
    v_mfma_f32_16x16x32_bf16 v[128:131], v[52:55], v[88:91], v[128:131]
    s_waitcnt lgkmcnt(1)
    s_add_u32 m0, s29, 4096
    s_add_u32 s32, s47, 6291456
    buffer_load_dwordx4 v15, s[12:15], s32 offen  lds
    v_mfma_f32_16x16x32_bf16 v[132:135], v[56:59], v[88:91], v[132:135]
    v_mfma_f32_16x16x32_bf16 v[136:139], v[60:63], v[88:91], v[136:139]
    buffer_load_dwordx4 v16, s[12:15], s32 offen offset:1024  lds
    v_mfma_f32_16x16x32_bf16 v[140:143], v[64:67], v[88:91], v[140:143]
    v_mfma_f32_16x16x32_bf16 v[144:147], v[52:55], v[92:95], v[144:147]
    buffer_load_dwordx4 v17, s[12:15], s32 offen offset:2048  lds
    v_mfma_f32_16x16x32_bf16 v[148:151], v[56:59], v[92:95], v[148:151]
    v_mfma_f32_16x16x32_bf16 v[152:155], v[60:63], v[92:95], v[152:155]
    buffer_load_dwordx4 v18, s[12:15], s32 offen offset:3072  lds
    v_mfma_f32_16x16x32_bf16 v[156:159], v[64:67], v[92:95], v[156:159]
    v_mfma_f32_16x16x32_bf16 v[160:163], v[52:55], v[96:99], v[160:163]
    s_waitcnt vmcnt(16)
    ds_read_b64_tr_b16 v[68:69], v11 offset:8192
    v_mfma_f32_16x16x32_bf16 v[164:167], v[56:59], v[96:99], v[164:167]
    v_mfma_f32_16x16x32_bf16 v[168:171], v[60:63], v[96:99], v[168:171]
    ds_read_b64_tr_b16 v[70:71], v11 offset:8704
    v_mfma_f32_16x16x32_bf16 v[172:175], v[64:67], v[96:99], v[172:175]
    v_mfma_f32_16x16x32_bf16 v[176:179], v[52:55], v[100:103], v[176:179]
    ds_read_b64_tr_b16 v[72:73], v12 offset:8192
    v_mfma_f32_16x16x32_bf16 v[180:183], v[56:59], v[100:103], v[180:183]
    v_mfma_f32_16x16x32_bf16 v[184:187], v[60:63], v[100:103], v[184:187]
    ds_read_b64_tr_b16 v[74:75], v12 offset:8704
    v_mfma_f32_16x16x32_bf16 v[188:191], v[64:67], v[100:103], v[188:191]
    v_mfma_f32_16x16x32_bf16 v[192:195], v[52:55], v[104:107], v[192:195]
    ds_read_b64_tr_b16 v[76:77], v13 offset:8192
    v_mfma_f32_16x16x32_bf16 v[196:199], v[56:59], v[104:107], v[196:199]
    v_mfma_f32_16x16x32_bf16 v[200:203], v[60:63], v[104:107], v[200:203]
    ds_read_b64_tr_b16 v[78:79], v13 offset:8704
    v_mfma_f32_16x16x32_bf16 v[204:207], v[64:67], v[104:107], v[204:207]
    v_mfma_f32_16x16x32_bf16 v[208:211], v[52:55], v[108:111], v[208:211]
    ds_read_b64_tr_b16 v[80:81], v14 offset:8192
    v_mfma_f32_16x16x32_bf16 v[212:215], v[56:59], v[108:111], v[212:215]
    v_mfma_f32_16x16x32_bf16 v[216:219], v[60:63], v[108:111], v[216:219]
    ds_read_b64_tr_b16 v[82:83], v14 offset:8704
    v_mfma_f32_16x16x32_bf16 v[220:223], v[64:67], v[108:111], v[220:223]
    v_mfma_f32_16x16x32_bf16 v[224:227], v[52:55], v[112:115], v[224:227]
    v_mfma_f32_16x16x32_bf16 v[228:231], v[56:59], v[112:115], v[228:231]
    v_mfma_f32_16x16x32_bf16 v[232:235], v[60:63], v[112:115], v[232:235]
    ds_read_b128 v[84:87], v29 offset:13824
    v_mfma_f32_16x16x32_bf16 v[236:239], v[64:67], v[112:115], v[236:239]
    v_mfma_f32_16x16x32_bf16 v[240:243], v[52:55], v[116:119], v[240:243]
    v_mfma_f32_16x16x32_bf16 v[244:247], v[56:59], v[116:119], v[244:247]
    v_mfma_f32_16x16x32_bf16 v[248:251], v[60:63], v[116:119], v[248:251]
    v_mfma_f32_16x16x32_bf16 v[252:255], v[64:67], v[116:119], v[252:255]
    s_waitcnt lgkmcnt(7)
    v_mfma_f32_16x16x32_bf16 v[128:131], v[68:71], v[92:95], v[128:131]
    s_waitcnt lgkmcnt(1)
    s_add_u32 m0, s29, 8192
    s_add_u32 s32, s47, 7340032
    buffer_load_dwordx4 v15, s[12:15], s32 offen  lds
    v_mfma_f32_16x16x32_bf16 v[132:135], v[72:75], v[92:95], v[132:135]
    v_mfma_f32_16x16x32_bf16 v[136:139], v[76:79], v[92:95], v[136:139]
    buffer_load_dwordx4 v16, s[12:15], s32 offen offset:1024  lds
    v_mfma_f32_16x16x32_bf16 v[140:143], v[80:83], v[92:95], v[140:143]
    v_mfma_f32_16x16x32_bf16 v[144:147], v[68:71], v[96:99], v[144:147]
    buffer_load_dwordx4 v17, s[12:15], s32 offen offset:2048  lds
    v_mfma_f32_16x16x32_bf16 v[148:151], v[72:75], v[96:99], v[148:151]
    v_mfma_f32_16x16x32_bf16 v[152:155], v[76:79], v[96:99], v[152:155]
    buffer_load_dwordx4 v18, s[12:15], s32 offen offset:3072  lds
    v_mfma_f32_16x16x32_bf16 v[156:159], v[80:83], v[96:99], v[156:159]
    v_mfma_f32_16x16x32_bf16 v[160:163], v[68:71], v[100:103], v[160:163]
    s_waitcnt vmcnt(16)
    ds_read_b64_tr_b16 v[36:37], v11 offset:12288
    v_mfma_f32_16x16x32_bf16 v[164:167], v[72:75], v[100:103], v[164:167]
    v_mfma_f32_16x16x32_bf16 v[168:171], v[76:79], v[100:103], v[168:171]
    ds_read_b64_tr_b16 v[38:39], v11 offset:12800
    v_mfma_f32_16x16x32_bf16 v[172:175], v[80:83], v[100:103], v[172:175]
    v_mfma_f32_16x16x32_bf16 v[176:179], v[68:71], v[104:107], v[176:179]
    ds_read_b64_tr_b16 v[40:41], v12 offset:12288
    v_mfma_f32_16x16x32_bf16 v[180:183], v[72:75], v[104:107], v[180:183]
    v_mfma_f32_16x16x32_bf16 v[184:187], v[76:79], v[104:107], v[184:187]
    ds_read_b64_tr_b16 v[42:43], v12 offset:12800
    v_mfma_f32_16x16x32_bf16 v[188:191], v[80:83], v[104:107], v[188:191]
    v_mfma_f32_16x16x32_bf16 v[192:195], v[68:71], v[108:111], v[192:195]
    ds_read_b64_tr_b16 v[44:45], v13 offset:12288
    v_mfma_f32_16x16x32_bf16 v[196:199], v[72:75], v[108:111], v[196:199]
    v_mfma_f32_16x16x32_bf16 v[200:203], v[76:79], v[108:111], v[200:203]
    ds_read_b64_tr_b16 v[46:47], v13 offset:12800
    v_mfma_f32_16x16x32_bf16 v[204:207], v[80:83], v[108:111], v[204:207]
    v_mfma_f32_16x16x32_bf16 v[208:211], v[68:71], v[112:115], v[208:211]
    ds_read_b64_tr_b16 v[48:49], v14 offset:12288
    v_mfma_f32_16x16x32_bf16 v[212:215], v[72:75], v[112:115], v[212:215]
    v_mfma_f32_16x16x32_bf16 v[216:219], v[76:79], v[112:115], v[216:219]
    ds_read_b64_tr_b16 v[50:51], v14 offset:12800
    v_mfma_f32_16x16x32_bf16 v[220:223], v[80:83], v[112:115], v[220:223]
    v_mfma_f32_16x16x32_bf16 v[224:227], v[68:71], v[116:119], v[224:227]
    v_mfma_f32_16x16x32_bf16 v[228:231], v[72:75], v[116:119], v[228:231]
    v_mfma_f32_16x16x32_bf16 v[232:235], v[76:79], v[116:119], v[232:235]
    ds_read_b128 v[88:91], v29 offset:18432
    v_mfma_f32_16x16x32_bf16 v[236:239], v[80:83], v[116:119], v[236:239]
    v_mfma_f32_16x16x32_bf16 v[240:243], v[68:71], v[120:123], v[240:243]
    v_mfma_f32_16x16x32_bf16 v[244:247], v[72:75], v[120:123], v[244:247]
    v_mfma_f32_16x16x32_bf16 v[248:251], v[76:79], v[120:123], v[248:251]
    v_mfma_f32_16x16x32_bf16 v[252:255], v[80:83], v[120:123], v[252:255]
    s_waitcnt lgkmcnt(7)
    v_mfma_f32_16x16x32_bf16 v[128:131], v[36:39], v[96:99], v[128:131]
    s_waitcnt lgkmcnt(1)
    s_add_u32 m0, s29, 12288
    s_add_u32 s32, s47, 8388608
    buffer_load_dwordx4 v15, s[12:15], s32 offen  lds
    v_mfma_f32_16x16x32_bf16 v[132:135], v[40:43], v[96:99], v[132:135]
    v_mfma_f32_16x16x32_bf16 v[136:139], v[44:47], v[96:99], v[136:139]
    buffer_load_dwordx4 v16, s[12:15], s32 offen offset:1024  lds
    v_mfma_f32_16x16x32_bf16 v[140:143], v[48:51], v[96:99], v[140:143]
    v_mfma_f32_16x16x32_bf16 v[144:147], v[36:39], v[100:103], v[144:147]
    buffer_load_dwordx4 v17, s[12:15], s32 offen offset:2048  lds
    v_mfma_f32_16x16x32_bf16 v[148:151], v[40:43], v[100:103], v[148:151]
    v_mfma_f32_16x16x32_bf16 v[152:155], v[44:47], v[100:103], v[152:155]
    buffer_load_dwordx4 v18, s[12:15], s32 offen offset:3072  lds
    v_mfma_f32_16x16x32_bf16 v[156:159], v[48:51], v[100:103], v[156:159]
    v_mfma_f32_16x16x32_bf16 v[160:163], v[36:39], v[104:107], v[160:163]
    s_waitcnt vmcnt(16)
    ds_read_b64_tr_b16 v[52:53], v11 offset:16384
    v_mfma_f32_16x16x32_bf16 v[164:167], v[40:43], v[104:107], v[164:167]
    v_mfma_f32_16x16x32_bf16 v[168:171], v[44:47], v[104:107], v[168:171]
    ds_read_b64_tr_b16 v[54:55], v11 offset:16896
    v_mfma_f32_16x16x32_bf16 v[172:175], v[48:51], v[104:107], v[172:175]
    v_mfma_f32_16x16x32_bf16 v[176:179], v[36:39], v[108:111], v[176:179]
    ds_read_b64_tr_b16 v[56:57], v12 offset:16384
    v_mfma_f32_16x16x32_bf16 v[180:183], v[40:43], v[108:111], v[180:183]
    v_mfma_f32_16x16x32_bf16 v[184:187], v[44:47], v[108:111], v[184:187]
    ds_read_b64_tr_b16 v[58:59], v12 offset:16896
    v_mfma_f32_16x16x32_bf16 v[188:191], v[48:51], v[108:111], v[188:191]
    v_mfma_f32_16x16x32_bf16 v[192:195], v[36:39], v[112:115], v[192:195]
    ds_read_b64_tr_b16 v[60:61], v13 offset:16384
    v_mfma_f32_16x16x32_bf16 v[196:199], v[40:43], v[112:115], v[196:199]
    v_mfma_f32_16x16x32_bf16 v[200:203], v[44:47], v[112:115], v[200:203]
    ds_read_b64_tr_b16 v[62:63], v13 offset:16896
    v_mfma_f32_16x16x32_bf16 v[204:207], v[48:51], v[112:115], v[204:207]
    v_mfma_f32_16x16x32_bf16 v[208:211], v[36:39], v[116:119], v[208:211]
    ds_read_b64_tr_b16 v[64:65], v14 offset:16384
    v_mfma_f32_16x16x32_bf16 v[212:215], v[40:43], v[116:119], v[212:215]
    v_mfma_f32_16x16x32_bf16 v[216:219], v[44:47], v[116:119], v[216:219]
    ds_read_b64_tr_b16 v[66:67], v14 offset:16896
    v_mfma_f32_16x16x32_bf16 v[220:223], v[48:51], v[116:119], v[220:223]
    v_mfma_f32_16x16x32_bf16 v[224:227], v[36:39], v[120:123], v[224:227]
    v_mfma_f32_16x16x32_bf16 v[228:231], v[40:43], v[120:123], v[228:231]
    v_mfma_f32_16x16x32_bf16 v[232:235], v[44:47], v[120:123], v[232:235]
    ds_read_b128 v[92:95], v29 offset:23040
    v_mfma_f32_16x16x32_bf16 v[236:239], v[48:51], v[120:123], v[236:239]
    v_mfma_f32_16x16x32_bf16 v[240:243], v[36:39], v[124:127], v[240:243]
    v_mfma_f32_16x16x32_bf16 v[244:247], v[40:43], v[124:127], v[244:247]
    v_mfma_f32_16x16x32_bf16 v[248:251], v[44:47], v[124:127], v[248:251]
    v_mfma_f32_16x16x32_bf16 v[252:255], v[48:51], v[124:127], v[252:255]
    s_waitcnt lgkmcnt(7)
    v_mfma_f32_16x16x32_bf16 v[128:131], v[52:55], v[100:103], v[128:131]
    s_waitcnt lgkmcnt(1)
    s_add_u32 m0, s29, 16384
    s_add_u32 s32, s47, 9437184
    buffer_load_dwordx4 v15, s[12:15], s32 offen  lds
    v_mfma_f32_16x16x32_bf16 v[132:135], v[56:59], v[100:103], v[132:135]
    v_mfma_f32_16x16x32_bf16 v[136:139], v[60:63], v[100:103], v[136:139]
    buffer_load_dwordx4 v16, s[12:15], s32 offen offset:1024  lds
    v_mfma_f32_16x16x32_bf16 v[140:143], v[64:67], v[100:103], v[140:143]
    v_mfma_f32_16x16x32_bf16 v[144:147], v[52:55], v[104:107], v[144:147]
    buffer_load_dwordx4 v17, s[12:15], s32 offen offset:2048  lds
    v_mfma_f32_16x16x32_bf16 v[148:151], v[56:59], v[104:107], v[148:151]
    v_mfma_f32_16x16x32_bf16 v[152:155], v[60:63], v[104:107], v[152:155]
    buffer_load_dwordx4 v18, s[12:15], s32 offen offset:3072  lds
    v_mfma_f32_16x16x32_bf16 v[156:159], v[64:67], v[104:107], v[156:159]
    v_mfma_f32_16x16x32_bf16 v[160:163], v[52:55], v[108:111], v[160:163]
    s_waitcnt vmcnt(16)
    ds_read_b64_tr_b16 v[68:69], v11 offset:0
    v_mfma_f32_16x16x32_bf16 v[164:167], v[56:59], v[108:111], v[164:167]
    v_mfma_f32_16x16x32_bf16 v[168:171], v[60:63], v[108:111], v[168:171]
    ds_read_b64_tr_b16 v[70:71], v11 offset:512
    v_mfma_f32_16x16x32_bf16 v[172:175], v[64:67], v[108:111], v[172:175]
    v_mfma_f32_16x16x32_bf16 v[176:179], v[52:55], v[112:115], v[176:179]
    ds_read_b64_tr_b16 v[72:73], v12 offset:0
    v_mfma_f32_16x16x32_bf16 v[180:183], v[56:59], v[112:115], v[180:183]
    v_mfma_f32_16x16x32_bf16 v[184:187], v[60:63], v[112:115], v[184:187]
    ds_read_b64_tr_b16 v[74:75], v12 offset:512
    v_mfma_f32_16x16x32_bf16 v[188:191], v[64:67], v[112:115], v[188:191]
    v_mfma_f32_16x16x32_bf16 v[192:195], v[52:55], v[116:119], v[192:195]
    ds_read_b64_tr_b16 v[76:77], v13 offset:0
    v_mfma_f32_16x16x32_bf16 v[196:199], v[56:59], v[116:119], v[196:199]
    v_mfma_f32_16x16x32_bf16 v[200:203], v[60:63], v[116:119], v[200:203]
    ds_read_b64_tr_b16 v[78:79], v13 offset:512
    v_mfma_f32_16x16x32_bf16 v[204:207], v[64:67], v[116:119], v[204:207]
    v_mfma_f32_16x16x32_bf16 v[208:211], v[52:55], v[120:123], v[208:211]
    ds_read_b64_tr_b16 v[80:81], v14 offset:0
    v_mfma_f32_16x16x32_bf16 v[212:215], v[56:59], v[120:123], v[212:215]
    v_mfma_f32_16x16x32_bf16 v[216:219], v[60:63], v[120:123], v[216:219]
    ds_read_b64_tr_b16 v[82:83], v14 offset:512
    v_mfma_f32_16x16x32_bf16 v[220:223], v[64:67], v[120:123], v[220:223]
    v_mfma_f32_16x16x32_bf16 v[224:227], v[52:55], v[124:127], v[224:227]
    v_mfma_f32_16x16x32_bf16 v[228:231], v[56:59], v[124:127], v[228:231]
    v_mfma_f32_16x16x32_bf16 v[232:235], v[60:63], v[124:127], v[232:235]
    ds_read_b128 v[96:99], v29 offset:27648
    v_mfma_f32_16x16x32_bf16 v[236:239], v[64:67], v[124:127], v[236:239]
    v_mfma_f32_16x16x32_bf16 v[240:243], v[52:55], v[84:87], v[240:243]
    v_mfma_f32_16x16x32_bf16 v[244:247], v[56:59], v[84:87], v[244:247]
    v_mfma_f32_16x16x32_bf16 v[248:251], v[60:63], v[84:87], v[248:251]
    v_mfma_f32_16x16x32_bf16 v[252:255], v[64:67], v[84:87], v[252:255]
    s_waitcnt lgkmcnt(7)
    v_mfma_f32_16x16x32_bf16 v[128:131], v[68:71], v[104:107], v[128:131]
    s_waitcnt lgkmcnt(1)
    s_add_u32 m0, s29, 0
    s_add_u32 s32, s47, 10485760
    buffer_load_dwordx4 v15, s[12:15], s32 offen  lds
    v_mfma_f32_16x16x32_bf16 v[132:135], v[72:75], v[104:107], v[132:135]
    v_mfma_f32_16x16x32_bf16 v[136:139], v[76:79], v[104:107], v[136:139]
    buffer_load_dwordx4 v16, s[12:15], s32 offen offset:1024  lds
    v_mfma_f32_16x16x32_bf16 v[140:143], v[80:83], v[104:107], v[140:143]
    v_mfma_f32_16x16x32_bf16 v[144:147], v[68:71], v[108:111], v[144:147]
    buffer_load_dwordx4 v17, s[12:15], s32 offen offset:2048  lds
    v_mfma_f32_16x16x32_bf16 v[148:151], v[72:75], v[108:111], v[148:151]
    v_mfma_f32_16x16x32_bf16 v[152:155], v[76:79], v[108:111], v[152:155]
    buffer_load_dwordx4 v18, s[12:15], s32 offen offset:3072  lds
    v_mfma_f32_16x16x32_bf16 v[156:159], v[80:83], v[108:111], v[156:159]
    v_mfma_f32_16x16x32_bf16 v[160:163], v[68:71], v[112:115], v[160:163]
    s_waitcnt vmcnt(16)
    ds_read_b64_tr_b16 v[36:37], v11 offset:4096
    v_mfma_f32_16x16x32_bf16 v[164:167], v[72:75], v[112:115], v[164:167]
    v_mfma_f32_16x16x32_bf16 v[168:171], v[76:79], v[112:115], v[168:171]
    ds_read_b64_tr_b16 v[38:39], v11 offset:4608
    v_mfma_f32_16x16x32_bf16 v[172:175], v[80:83], v[112:115], v[172:175]
    v_mfma_f32_16x16x32_bf16 v[176:179], v[68:71], v[116:119], v[176:179]
    ds_read_b64_tr_b16 v[40:41], v12 offset:4096
    v_mfma_f32_16x16x32_bf16 v[180:183], v[72:75], v[116:119], v[180:183]
    v_mfma_f32_16x16x32_bf16 v[184:187], v[76:79], v[116:119], v[184:187]
    ds_read_b64_tr_b16 v[42:43], v12 offset:4608
    v_mfma_f32_16x16x32_bf16 v[188:191], v[80:83], v[116:119], v[188:191]
    v_mfma_f32_16x16x32_bf16 v[192:195], v[68:71], v[120:123], v[192:195]
    ds_read_b64_tr_b16 v[44:45], v13 offset:4096
    v_mfma_f32_16x16x32_bf16 v[196:199], v[72:75], v[120:123], v[196:199]
    v_mfma_f32_16x16x32_bf16 v[200:203], v[76:79], v[120:123], v[200:203]
    ds_read_b64_tr_b16 v[46:47], v13 offset:4608
    v_mfma_f32_16x16x32_bf16 v[204:207], v[80:83], v[120:123], v[204:207]
    v_mfma_f32_16x16x32_bf16 v[208:211], v[68:71], v[124:127], v[208:211]
    ds_read_b64_tr_b16 v[48:49], v14 offset:4096
    v_mfma_f32_16x16x32_bf16 v[212:215], v[72:75], v[124:127], v[212:215]
    v_mfma_f32_16x16x32_bf16 v[216:219], v[76:79], v[124:127], v[216:219]
    ds_read_b64_tr_b16 v[50:51], v14 offset:4608
    v_mfma_f32_16x16x32_bf16 v[220:223], v[80:83], v[124:127], v[220:223]
    v_mfma_f32_16x16x32_bf16 v[224:227], v[68:71], v[84:87], v[224:227]
    v_mfma_f32_16x16x32_bf16 v[228:231], v[72:75], v[84:87], v[228:231]
    v_mfma_f32_16x16x32_bf16 v[232:235], v[76:79], v[84:87], v[232:235]
    ds_read_b128 v[100:103], v29 offset:32256
    v_mfma_f32_16x16x32_bf16 v[236:239], v[80:83], v[84:87], v[236:239]
    v_mfma_f32_16x16x32_bf16 v[240:243], v[68:71], v[88:91], v[240:243]
    v_mfma_f32_16x16x32_bf16 v[244:247], v[72:75], v[88:91], v[244:247]
    v_mfma_f32_16x16x32_bf16 v[248:251], v[76:79], v[88:91], v[248:251]
    v_mfma_f32_16x16x32_bf16 v[252:255], v[80:83], v[88:91], v[252:255]
    s_waitcnt lgkmcnt(7)
    v_mfma_f32_16x16x32_bf16 v[128:131], v[36:39], v[108:111], v[128:131]
    s_waitcnt lgkmcnt(1)
    s_add_u32 m0, s29, 4096
    s_add_u32 s32, s47, 11534336
    buffer_load_dwordx4 v15, s[12:15], s32 offen  lds
    v_mfma_f32_16x16x32_bf16 v[132:135], v[40:43], v[108:111], v[132:135]
    v_mfma_f32_16x16x32_bf16 v[136:139], v[44:47], v[108:111], v[136:139]
    buffer_load_dwordx4 v16, s[12:15], s32 offen offset:1024  lds
    v_mfma_f32_16x16x32_bf16 v[140:143], v[48:51], v[108:111], v[140:143]
    v_mfma_f32_16x16x32_bf16 v[144:147], v[36:39], v[112:115], v[144:147]
    buffer_load_dwordx4 v17, s[12:15], s32 offen offset:2048  lds
    v_mfma_f32_16x16x32_bf16 v[148:151], v[40:43], v[112:115], v[148:151]
    v_mfma_f32_16x16x32_bf16 v[152:155], v[44:47], v[112:115], v[152:155]
    buffer_load_dwordx4 v18, s[12:15], s32 offen offset:3072  lds
    v_mfma_f32_16x16x32_bf16 v[156:159], v[48:51], v[112:115], v[156:159]
    v_mfma_f32_16x16x32_bf16 v[160:163], v[36:39], v[116:119], v[160:163]
    s_waitcnt vmcnt(16)
    ds_read_b64_tr_b16 v[52:53], v11 offset:8192
    v_mfma_f32_16x16x32_bf16 v[164:167], v[40:43], v[116:119], v[164:167]
    v_mfma_f32_16x16x32_bf16 v[168:171], v[44:47], v[116:119], v[168:171]
    ds_read_b64_tr_b16 v[54:55], v11 offset:8704
    v_mfma_f32_16x16x32_bf16 v[172:175], v[48:51], v[116:119], v[172:175]
    v_mfma_f32_16x16x32_bf16 v[176:179], v[36:39], v[120:123], v[176:179]
    ds_read_b64_tr_b16 v[56:57], v12 offset:8192
    v_mfma_f32_16x16x32_bf16 v[180:183], v[40:43], v[120:123], v[180:183]
    v_mfma_f32_16x16x32_bf16 v[184:187], v[44:47], v[120:123], v[184:187]
    ds_read_b64_tr_b16 v[58:59], v12 offset:8704
    v_mfma_f32_16x16x32_bf16 v[188:191], v[48:51], v[120:123], v[188:191]
    v_mfma_f32_16x16x32_bf16 v[192:195], v[36:39], v[124:127], v[192:195]
    ds_read_b64_tr_b16 v[60:61], v13 offset:8192
    v_mfma_f32_16x16x32_bf16 v[196:199], v[40:43], v[124:127], v[196:199]
    v_mfma_f32_16x16x32_bf16 v[200:203], v[44:47], v[124:127], v[200:203]
    ds_read_b64_tr_b16 v[62:63], v13 offset:8704
    v_mfma_f32_16x16x32_bf16 v[204:207], v[48:51], v[124:127], v[204:207]
    v_mfma_f32_16x16x32_bf16 v[208:211], v[36:39], v[84:87], v[208:211]
    ds_read_b64_tr_b16 v[64:65], v14 offset:8192
    v_mfma_f32_16x16x32_bf16 v[212:215], v[40:43], v[84:87], v[212:215]
    v_mfma_f32_16x16x32_bf16 v[216:219], v[44:47], v[84:87], v[216:219]
    ds_read_b64_tr_b16 v[66:67], v14 offset:8704
    v_mfma_f32_16x16x32_bf16 v[220:223], v[48:51], v[84:87], v[220:223]
    v_mfma_f32_16x16x32_bf16 v[224:227], v[36:39], v[88:91], v[224:227]
    v_mfma_f32_16x16x32_bf16 v[228:231], v[40:43], v[88:91], v[228:231]
    v_mfma_f32_16x16x32_bf16 v[232:235], v[44:47], v[88:91], v[232:235]
    ds_read_b128 v[104:107], v30 offset:0
    v_mfma_f32_16x16x32_bf16 v[236:239], v[48:51], v[88:91], v[236:239]
    v_mfma_f32_16x16x32_bf16 v[240:243], v[36:39], v[92:95], v[240:243]
    v_mfma_f32_16x16x32_bf16 v[244:247], v[40:43], v[92:95], v[244:247]
    v_mfma_f32_16x16x32_bf16 v[248:251], v[44:47], v[92:95], v[248:251]
    v_mfma_f32_16x16x32_bf16 v[252:255], v[48:51], v[92:95], v[252:255]
    s_waitcnt lgkmcnt(7)
    v_mfma_f32_16x16x32_bf16 v[128:131], v[52:55], v[112:115], v[128:131]
    s_waitcnt lgkmcnt(1)
    s_add_u32 m0, s29, 8192
    s_add_u32 s32, s47, 12582912
    buffer_load_dwordx4 v15, s[12:15], s32 offen  lds
    v_mfma_f32_16x16x32_bf16 v[132:135], v[56:59], v[112:115], v[132:135]
    v_mfma_f32_16x16x32_bf16 v[136:139], v[60:63], v[112:115], v[136:139]
    buffer_load_dwordx4 v16, s[12:15], s32 offen offset:1024  lds
    v_mfma_f32_16x16x32_bf16 v[140:143], v[64:67], v[112:115], v[140:143]
    v_mfma_f32_16x16x32_bf16 v[144:147], v[52:55], v[116:119], v[144:147]
    buffer_load_dwordx4 v17, s[12:15], s32 offen offset:2048  lds
    v_mfma_f32_16x16x32_bf16 v[148:151], v[56:59], v[116:119], v[148:151]
    v_mfma_f32_16x16x32_bf16 v[152:155], v[60:63], v[116:119], v[152:155]
    buffer_load_dwordx4 v18, s[12:15], s32 offen offset:3072  lds
    v_mfma_f32_16x16x32_bf16 v[156:159], v[64:67], v[116:119], v[156:159]
    v_mfma_f32_16x16x32_bf16 v[160:163], v[52:55], v[120:123], v[160:163]
    s_waitcnt vmcnt(16)
    ds_read_b64_tr_b16 v[68:69], v11 offset:12288
    v_mfma_f32_16x16x32_bf16 v[164:167], v[56:59], v[120:123], v[164:167]
    v_mfma_f32_16x16x32_bf16 v[168:171], v[60:63], v[120:123], v[168:171]
    ds_read_b64_tr_b16 v[70:71], v11 offset:12800
    v_mfma_f32_16x16x32_bf16 v[172:175], v[64:67], v[120:123], v[172:175]
    v_mfma_f32_16x16x32_bf16 v[176:179], v[52:55], v[124:127], v[176:179]
    ds_read_b64_tr_b16 v[72:73], v12 offset:12288
    v_mfma_f32_16x16x32_bf16 v[180:183], v[56:59], v[124:127], v[180:183]
    v_mfma_f32_16x16x32_bf16 v[184:187], v[60:63], v[124:127], v[184:187]
    ds_read_b64_tr_b16 v[74:75], v12 offset:12800
    v_mfma_f32_16x16x32_bf16 v[188:191], v[64:67], v[124:127], v[188:191]
    v_mfma_f32_16x16x32_bf16 v[192:195], v[52:55], v[84:87], v[192:195]
    ds_read_b64_tr_b16 v[76:77], v13 offset:12288
    v_mfma_f32_16x16x32_bf16 v[196:199], v[56:59], v[84:87], v[196:199]
    v_mfma_f32_16x16x32_bf16 v[200:203], v[60:63], v[84:87], v[200:203]
    ds_read_b64_tr_b16 v[78:79], v13 offset:12800
    v_mfma_f32_16x16x32_bf16 v[204:207], v[64:67], v[84:87], v[204:207]
    v_mfma_f32_16x16x32_bf16 v[208:211], v[52:55], v[88:91], v[208:211]
    ds_read_b64_tr_b16 v[80:81], v14 offset:12288
    v_mfma_f32_16x16x32_bf16 v[212:215], v[56:59], v[88:91], v[212:215]
    v_mfma_f32_16x16x32_bf16 v[216:219], v[60:63], v[88:91], v[216:219]
    ds_read_b64_tr_b16 v[82:83], v14 offset:12800
    v_mfma_f32_16x16x32_bf16 v[220:223], v[64:67], v[88:91], v[220:223]
    v_mfma_f32_16x16x32_bf16 v[224:227], v[52:55], v[92:95], v[224:227]
    v_mfma_f32_16x16x32_bf16 v[228:231], v[56:59], v[92:95], v[228:231]
    v_mfma_f32_16x16x32_bf16 v[232:235], v[60:63], v[92:95], v[232:235]
    ds_read_b128 v[108:111], v30 offset:4608
    v_mfma_f32_16x16x32_bf16 v[236:239], v[64:67], v[92:95], v[236:239]
    v_mfma_f32_16x16x32_bf16 v[240:243], v[52:55], v[96:99], v[240:243]
    v_mfma_f32_16x16x32_bf16 v[244:247], v[56:59], v[96:99], v[244:247]
    v_mfma_f32_16x16x32_bf16 v[248:251], v[60:63], v[96:99], v[248:251]
    v_mfma_f32_16x16x32_bf16 v[252:255], v[64:67], v[96:99], v[252:255]
    s_waitcnt lgkmcnt(7)
    v_mfma_f32_16x16x32_bf16 v[128:131], v[68:71], v[116:119], v[128:131]
    s_waitcnt lgkmcnt(1)
    s_add_u32 m0, s29, 12288
    s_add_u32 s32, s47, 13631488
    buffer_load_dwordx4 v15, s[12:15], s32 offen  lds
    v_mfma_f32_16x16x32_bf16 v[132:135], v[72:75], v[116:119], v[132:135]
    v_mfma_f32_16x16x32_bf16 v[136:139], v[76:79], v[116:119], v[136:139]
    buffer_load_dwordx4 v16, s[12:15], s32 offen offset:1024  lds
    v_mfma_f32_16x16x32_bf16 v[140:143], v[80:83], v[116:119], v[140:143]
    v_mfma_f32_16x16x32_bf16 v[144:147], v[68:71], v[120:123], v[144:147]
    buffer_load_dwordx4 v17, s[12:15], s32 offen offset:2048  lds
    v_mfma_f32_16x16x32_bf16 v[148:151], v[72:75], v[120:123], v[148:151]
    v_mfma_f32_16x16x32_bf16 v[152:155], v[76:79], v[120:123], v[152:155]
    buffer_load_dwordx4 v18, s[12:15], s32 offen offset:3072  lds
    v_mfma_f32_16x16x32_bf16 v[156:159], v[80:83], v[120:123], v[156:159]
    v_mfma_f32_16x16x32_bf16 v[160:163], v[68:71], v[124:127], v[160:163]
    s_waitcnt vmcnt(16)
    ds_read_b64_tr_b16 v[36:37], v11 offset:16384
    v_mfma_f32_16x16x32_bf16 v[164:167], v[72:75], v[124:127], v[164:167]
    v_mfma_f32_16x16x32_bf16 v[168:171], v[76:79], v[124:127], v[168:171]
    ds_read_b64_tr_b16 v[38:39], v11 offset:16896
    v_mfma_f32_16x16x32_bf16 v[172:175], v[80:83], v[124:127], v[172:175]
    v_mfma_f32_16x16x32_bf16 v[176:179], v[68:71], v[84:87], v[176:179]
    ds_read_b64_tr_b16 v[40:41], v12 offset:16384
    v_mfma_f32_16x16x32_bf16 v[180:183], v[72:75], v[84:87], v[180:183]
    v_mfma_f32_16x16x32_bf16 v[184:187], v[76:79], v[84:87], v[184:187]
    ds_read_b64_tr_b16 v[42:43], v12 offset:16896
    v_mfma_f32_16x16x32_bf16 v[188:191], v[80:83], v[84:87], v[188:191]
    v_mfma_f32_16x16x32_bf16 v[192:195], v[68:71], v[88:91], v[192:195]
    ds_read_b64_tr_b16 v[44:45], v13 offset:16384
    v_mfma_f32_16x16x32_bf16 v[196:199], v[72:75], v[88:91], v[196:199]
    v_mfma_f32_16x16x32_bf16 v[200:203], v[76:79], v[88:91], v[200:203]
    ds_read_b64_tr_b16 v[46:47], v13 offset:16896
    v_mfma_f32_16x16x32_bf16 v[204:207], v[80:83], v[88:91], v[204:207]
    v_mfma_f32_16x16x32_bf16 v[208:211], v[68:71], v[92:95], v[208:211]
    ds_read_b64_tr_b16 v[48:49], v14 offset:16384
    v_mfma_f32_16x16x32_bf16 v[212:215], v[72:75], v[92:95], v[212:215]
    v_mfma_f32_16x16x32_bf16 v[216:219], v[76:79], v[92:95], v[216:219]
    ds_read_b64_tr_b16 v[50:51], v14 offset:16896
    v_mfma_f32_16x16x32_bf16 v[220:223], v[80:83], v[92:95], v[220:223]
    v_mfma_f32_16x16x32_bf16 v[224:227], v[68:71], v[96:99], v[224:227]
    v_mfma_f32_16x16x32_bf16 v[228:231], v[72:75], v[96:99], v[228:231]
    v_mfma_f32_16x16x32_bf16 v[232:235], v[76:79], v[96:99], v[232:235]
    ds_read_b128 v[112:115], v30 offset:9216
    v_mfma_f32_16x16x32_bf16 v[236:239], v[80:83], v[96:99], v[236:239]
    v_mfma_f32_16x16x32_bf16 v[240:243], v[68:71], v[100:103], v[240:243]
    v_mfma_f32_16x16x32_bf16 v[244:247], v[72:75], v[100:103], v[244:247]
    v_mfma_f32_16x16x32_bf16 v[248:251], v[76:79], v[100:103], v[248:251]
    v_mfma_f32_16x16x32_bf16 v[252:255], v[80:83], v[100:103], v[252:255]
    s_waitcnt lgkmcnt(7)
    v_mfma_f32_16x16x32_bf16 v[128:131], v[36:39], v[120:123], v[128:131]
    s_waitcnt lgkmcnt(1)
    s_add_u32 m0, s29, 16384
    s_add_u32 s32, s47, 14680064
    buffer_load_dwordx4 v15, s[12:15], s32 offen  lds
    v_mfma_f32_16x16x32_bf16 v[132:135], v[40:43], v[120:123], v[132:135]
    v_mfma_f32_16x16x32_bf16 v[136:139], v[44:47], v[120:123], v[136:139]
    buffer_load_dwordx4 v16, s[12:15], s32 offen offset:1024  lds
    v_mfma_f32_16x16x32_bf16 v[140:143], v[48:51], v[120:123], v[140:143]
    v_mfma_f32_16x16x32_bf16 v[144:147], v[36:39], v[124:127], v[144:147]
    buffer_load_dwordx4 v17, s[12:15], s32 offen offset:2048  lds
    v_mfma_f32_16x16x32_bf16 v[148:151], v[40:43], v[124:127], v[148:151]
    v_mfma_f32_16x16x32_bf16 v[152:155], v[44:47], v[124:127], v[152:155]
    buffer_load_dwordx4 v18, s[12:15], s32 offen offset:3072  lds
    v_mfma_f32_16x16x32_bf16 v[156:159], v[48:51], v[124:127], v[156:159]
    v_mfma_f32_16x16x32_bf16 v[160:163], v[36:39], v[84:87], v[160:163]
    s_waitcnt vmcnt(16)
    ds_read_b64_tr_b16 v[52:53], v11 offset:0
    v_mfma_f32_16x16x32_bf16 v[164:167], v[40:43], v[84:87], v[164:167]
    v_mfma_f32_16x16x32_bf16 v[168:171], v[44:47], v[84:87], v[168:171]
    ds_read_b64_tr_b16 v[54:55], v11 offset:512
    v_mfma_f32_16x16x32_bf16 v[172:175], v[48:51], v[84:87], v[172:175]
    v_mfma_f32_16x16x32_bf16 v[176:179], v[36:39], v[88:91], v[176:179]
    ds_read_b64_tr_b16 v[56:57], v12 offset:0
    v_mfma_f32_16x16x32_bf16 v[180:183], v[40:43], v[88:91], v[180:183]
    v_mfma_f32_16x16x32_bf16 v[184:187], v[44:47], v[88:91], v[184:187]
    ds_read_b64_tr_b16 v[58:59], v12 offset:512
    v_mfma_f32_16x16x32_bf16 v[188:191], v[48:51], v[88:91], v[188:191]
    v_mfma_f32_16x16x32_bf16 v[192:195], v[36:39], v[92:95], v[192:195]
    ds_read_b64_tr_b16 v[60:61], v13 offset:0
    v_mfma_f32_16x16x32_bf16 v[196:199], v[40:43], v[92:95], v[196:199]
    v_mfma_f32_16x16x32_bf16 v[200:203], v[44:47], v[92:95], v[200:203]
    ds_read_b64_tr_b16 v[62:63], v13 offset:512
    v_mfma_f32_16x16x32_bf16 v[204:207], v[48:51], v[92:95], v[204:207]
    v_mfma_f32_16x16x32_bf16 v[208:211], v[36:39], v[96:99], v[208:211]
    ds_read_b64_tr_b16 v[64:65], v14 offset:0
    v_mfma_f32_16x16x32_bf16 v[212:215], v[40:43], v[96:99], v[212:215]
    v_mfma_f32_16x16x32_bf16 v[216:219], v[44:47], v[96:99], v[216:219]
    ds_read_b64_tr_b16 v[66:67], v14 offset:512
    v_mfma_f32_16x16x32_bf16 v[220:223], v[48:51], v[96:99], v[220:223]
    v_mfma_f32_16x16x32_bf16 v[224:227], v[36:39], v[100:103], v[224:227]
    v_mfma_f32_16x16x32_bf16 v[228:231], v[40:43], v[100:103], v[228:231]
    v_mfma_f32_16x16x32_bf16 v[232:235], v[44:47], v[100:103], v[232:235]
    ds_read_b128 v[116:119], v30 offset:13824
    v_mfma_f32_16x16x32_bf16 v[236:239], v[48:51], v[100:103], v[236:239]
    v_mfma_f32_16x16x32_bf16 v[240:243], v[36:39], v[104:107], v[240:243]
    v_mfma_f32_16x16x32_bf16 v[244:247], v[40:43], v[104:107], v[244:247]
    v_mfma_f32_16x16x32_bf16 v[248:251], v[44:47], v[104:107], v[248:251]
    v_mfma_f32_16x16x32_bf16 v[252:255], v[48:51], v[104:107], v[252:255]
    s_waitcnt lgkmcnt(7)
    v_mfma_f32_16x16x32_bf16 v[128:131], v[52:55], v[124:127], v[128:131]
    s_waitcnt lgkmcnt(5)
    v_mfma_f32_16x16x32_bf16 v[132:135], v[56:59], v[124:127], v[132:135]
    s_waitcnt lgkmcnt(3)
    v_mfma_f32_16x16x32_bf16 v[136:139], v[60:63], v[124:127], v[136:139]
    s_waitcnt lgkmcnt(1)
    v_mfma_f32_16x16x32_bf16 v[140:143], v[64:67], v[124:127], v[140:143]
    v_mfma_f32_16x16x32_bf16 v[144:147], v[52:55], v[84:87], v[144:147]
    v_mfma_f32_16x16x32_bf16 v[148:151], v[56:59], v[84:87], v[148:151]
    v_mfma_f32_16x16x32_bf16 v[152:155], v[60:63], v[84:87], v[152:155]
    v_mfma_f32_16x16x32_bf16 v[156:159], v[64:67], v[84:87], v[156:159]
    v_mfma_f32_16x16x32_bf16 v[160:163], v[52:55], v[88:91], v[160:163]
    s_waitcnt vmcnt(12)
    ds_read_b64_tr_b16 v[68:69], v11 offset:4096
    v_mfma_f32_16x16x32_bf16 v[164:167], v[56:59], v[88:91], v[164:167]
    v_mfma_f32_16x16x32_bf16 v[168:171], v[60:63], v[88:91], v[168:171]
    ds_read_b64_tr_b16 v[70:71], v11 offset:4608
    v_mfma_f32_16x16x32_bf16 v[172:175], v[64:67], v[88:91], v[172:175]
    v_mfma_f32_16x16x32_bf16 v[176:179], v[52:55], v[92:95], v[176:179]
    ds_read_b64_tr_b16 v[72:73], v12 offset:4096
    v_mfma_f32_16x16x32_bf16 v[180:183], v[56:59], v[92:95], v[180:183]
    v_mfma_f32_16x16x32_bf16 v[184:187], v[60:63], v[92:95], v[184:187]
    ds_read_b64_tr_b16 v[74:75], v12 offset:4608
    v_mfma_f32_16x16x32_bf16 v[188:191], v[64:67], v[92:95], v[188:191]
    v_mfma_f32_16x16x32_bf16 v[192:195], v[52:55], v[96:99], v[192:195]
    ds_read_b64_tr_b16 v[76:77], v13 offset:4096
    v_mfma_f32_16x16x32_bf16 v[196:199], v[56:59], v[96:99], v[196:199]
    v_mfma_f32_16x16x32_bf16 v[200:203], v[60:63], v[96:99], v[200:203]
    ds_read_b64_tr_b16 v[78:79], v13 offset:4608
    v_mfma_f32_16x16x32_bf16 v[204:207], v[64:67], v[96:99], v[204:207]
    v_mfma_f32_16x16x32_bf16 v[208:211], v[52:55], v[100:103], v[208:211]
    ds_read_b64_tr_b16 v[80:81], v14 offset:4096
    v_mfma_f32_16x16x32_bf16 v[212:215], v[56:59], v[100:103], v[212:215]
    v_mfma_f32_16x16x32_bf16 v[216:219], v[60:63], v[100:103], v[216:219]
    ds_read_b64_tr_b16 v[82:83], v14 offset:4608
    v_mfma_f32_16x16x32_bf16 v[220:223], v[64:67], v[100:103], v[220:223]
    v_mfma_f32_16x16x32_bf16 v[224:227], v[52:55], v[104:107], v[224:227]
    v_mfma_f32_16x16x32_bf16 v[228:231], v[56:59], v[104:107], v[228:231]
    v_mfma_f32_16x16x32_bf16 v[232:235], v[60:63], v[104:107], v[232:235]
    ds_read_b128 v[120:123], v30 offset:18432
    v_mfma_f32_16x16x32_bf16 v[236:239], v[64:67], v[104:107], v[236:239]
    v_mfma_f32_16x16x32_bf16 v[240:243], v[52:55], v[108:111], v[240:243]
    v_mfma_f32_16x16x32_bf16 v[244:247], v[56:59], v[108:111], v[244:247]
    v_mfma_f32_16x16x32_bf16 v[248:251], v[60:63], v[108:111], v[248:251]
    v_mfma_f32_16x16x32_bf16 v[252:255], v[64:67], v[108:111], v[252:255]
    s_waitcnt lgkmcnt(7)
    v_mfma_f32_16x16x32_bf16 v[128:131], v[68:71], v[84:87], v[128:131]
    s_waitcnt lgkmcnt(5)
    v_mfma_f32_16x16x32_bf16 v[132:135], v[72:75], v[84:87], v[132:135]
    s_waitcnt lgkmcnt(3)
    v_mfma_f32_16x16x32_bf16 v[136:139], v[76:79], v[84:87], v[136:139]
    s_waitcnt lgkmcnt(1)
    v_mfma_f32_16x16x32_bf16 v[140:143], v[80:83], v[84:87], v[140:143]
    v_mfma_f32_16x16x32_bf16 v[144:147], v[68:71], v[88:91], v[144:147]
    v_mfma_f32_16x16x32_bf16 v[148:151], v[72:75], v[88:91], v[148:151]
    v_mfma_f32_16x16x32_bf16 v[152:155], v[76:79], v[88:91], v[152:155]
    v_mfma_f32_16x16x32_bf16 v[156:159], v[80:83], v[88:91], v[156:159]
    v_mfma_f32_16x16x32_bf16 v[160:163], v[68:71], v[92:95], v[160:163]
    s_waitcnt vmcnt(8)
    ds_read_b64_tr_b16 v[36:37], v11 offset:8192
    v_mfma_f32_16x16x32_bf16 v[164:167], v[72:75], v[92:95], v[164:167]
    s_waitcnt vmcnt(4)
    ds_read_b64_tr_b16 v[52:53], v11 offset:12288
    v_mfma_f32_16x16x32_bf16 v[168:171], v[76:79], v[92:95], v[168:171]
    ds_read_b64_tr_b16 v[38:39], v11 offset:8704
    v_mfma_f32_16x16x32_bf16 v[172:175], v[80:83], v[92:95], v[172:175]
    ds_read_b64_tr_b16 v[54:55], v11 offset:12800
    v_mfma_f32_16x16x32_bf16 v[176:179], v[68:71], v[96:99], v[176:179]
    ds_read_b64_tr_b16 v[40:41], v12 offset:8192
    v_mfma_f32_16x16x32_bf16 v[180:183], v[72:75], v[96:99], v[180:183]
    ds_read_b64_tr_b16 v[56:57], v12 offset:12288
    v_mfma_f32_16x16x32_bf16 v[184:187], v[76:79], v[96:99], v[184:187]
    ds_read_b64_tr_b16 v[42:43], v12 offset:8704
    v_mfma_f32_16x16x32_bf16 v[188:191], v[80:83], v[96:99], v[188:191]
    ds_read_b64_tr_b16 v[58:59], v12 offset:12800
    v_mfma_f32_16x16x32_bf16 v[192:195], v[68:71], v[100:103], v[192:195]
    ds_read_b64_tr_b16 v[44:45], v13 offset:8192
    v_mfma_f32_16x16x32_bf16 v[196:199], v[72:75], v[100:103], v[196:199]
    ds_read_b64_tr_b16 v[60:61], v13 offset:12288
    v_mfma_f32_16x16x32_bf16 v[200:203], v[76:79], v[100:103], v[200:203]
    ds_read_b64_tr_b16 v[46:47], v13 offset:8704
    v_mfma_f32_16x16x32_bf16 v[204:207], v[80:83], v[100:103], v[204:207]
    ds_read_b64_tr_b16 v[62:63], v13 offset:12800
    v_mfma_f32_16x16x32_bf16 v[208:211], v[68:71], v[104:107], v[208:211]
    ds_read_b64_tr_b16 v[48:49], v14 offset:8192
    v_mfma_f32_16x16x32_bf16 v[212:215], v[72:75], v[104:107], v[212:215]
    ds_read_b64_tr_b16 v[64:65], v14 offset:12288
    v_mfma_f32_16x16x32_bf16 v[216:219], v[76:79], v[104:107], v[216:219]
    ds_read_b64_tr_b16 v[50:51], v14 offset:8704
    v_mfma_f32_16x16x32_bf16 v[220:223], v[80:83], v[104:107], v[220:223]
    ds_read_b64_tr_b16 v[66:67], v14 offset:12800
    v_mfma_f32_16x16x32_bf16 v[224:227], v[68:71], v[108:111], v[224:227]
    v_mfma_f32_16x16x32_bf16 v[228:231], v[72:75], v[108:111], v[228:231]
    v_mfma_f32_16x16x32_bf16 v[232:235], v[76:79], v[108:111], v[232:235]
    ds_read_b128 v[124:127], v30 offset:23040
    v_mfma_f32_16x16x32_bf16 v[236:239], v[80:83], v[108:111], v[236:239]
    v_mfma_f32_16x16x32_bf16 v[240:243], v[68:71], v[112:115], v[240:243]
    v_mfma_f32_16x16x32_bf16 v[244:247], v[72:75], v[112:115], v[244:247]
    v_mfma_f32_16x16x32_bf16 v[248:251], v[76:79], v[112:115], v[248:251]
    v_mfma_f32_16x16x32_bf16 v[252:255], v[80:83], v[112:115], v[252:255]
    s_waitcnt lgkmcnt(14)
    v_mfma_f32_16x16x32_bf16 v[128:131], v[36:39], v[88:91], v[128:131]
    s_waitcnt vmcnt(0)
    ds_read_b64_tr_b16 v[68:69], v11 offset:16384
    s_waitcnt lgkmcnt(11)
    v_mfma_f32_16x16x32_bf16 v[132:135], v[40:43], v[88:91], v[132:135]
    ds_read_b64_tr_b16 v[70:71], v11 offset:16896
    s_waitcnt lgkmcnt(8)
    v_mfma_f32_16x16x32_bf16 v[136:139], v[44:47], v[88:91], v[136:139]
    ds_read_b64_tr_b16 v[72:73], v12 offset:16384
    s_waitcnt lgkmcnt(5)
    v_mfma_f32_16x16x32_bf16 v[140:143], v[48:51], v[88:91], v[140:143]
    ds_read_b64_tr_b16 v[74:75], v12 offset:16896
    v_mfma_f32_16x16x32_bf16 v[144:147], v[36:39], v[92:95], v[144:147]
    ds_read_b64_tr_b16 v[76:77], v13 offset:16384
    v_mfma_f32_16x16x32_bf16 v[148:151], v[40:43], v[92:95], v[148:151]
    ds_read_b64_tr_b16 v[78:79], v13 offset:16896
    v_mfma_f32_16x16x32_bf16 v[152:155], v[44:47], v[92:95], v[152:155]
    ds_read_b64_tr_b16 v[80:81], v14 offset:16384
    v_mfma_f32_16x16x32_bf16 v[156:159], v[48:51], v[92:95], v[156:159]
    ds_read_b64_tr_b16 v[82:83], v14 offset:16896
    v_mfma_f32_16x16x32_bf16 v[128:131], v[52:55], v[92:95], v[128:131]
    v_add_u32 v4, s29, v34
    s_lshl_b32 s32, s28, 14
    v_add_u32 v5, s32, v34
    v_mfma_f32_16x16x32_bf16 v[132:135], v[56:59], v[92:95], v[132:135]
    v_mfma_f32_16x16x32_bf16 v[136:139], v[60:63], v[92:95], v[136:139]
    s_waitcnt lgkmcnt(8)
    s_barrier
    v_mfma_f32_16x16x32_bf16 v[140:143], v[64:67], v[92:95], v[140:143]
    v_mfma_f32_16x16x32_bf16 v[144:147], v[52:55], v[96:99], v[144:147]
    v_mfma_f32_16x16x32_bf16 v[148:151], v[56:59], v[96:99], v[148:151]
    v_mfma_f32_16x16x32_bf16 v[152:155], v[60:63], v[96:99], v[152:155]
    v_mfma_f32_16x16x32_bf16 v[156:159], v[64:67], v[96:99], v[156:159]
    s_waitcnt lgkmcnt(6)
    v_mfma_f32_16x16x32_bf16 v[128:131], v[68:71], v[96:99], v[128:131]
    s_waitcnt lgkmcnt(4)
    v_mfma_f32_16x16x32_bf16 v[132:135], v[72:75], v[96:99], v[132:135]
    s_waitcnt lgkmcnt(2)
    v_mfma_f32_16x16x32_bf16 v[136:139], v[76:79], v[96:99], v[136:139]
    s_waitcnt lgkmcnt(0)
    v_mfma_f32_16x16x32_bf16 v[140:143], v[80:83], v[96:99], v[140:143]
    v_mfma_f32_16x16x32_bf16 v[144:147], v[68:71], v[100:103], v[144:147]
    v_mfma_f32_16x16x32_bf16 v[148:151], v[72:75], v[100:103], v[148:151]
    v_mfma_f32_16x16x32_bf16 v[152:155], v[76:79], v[100:103], v[152:155]
    v_mfma_f32_16x16x32_bf16 v[156:159], v[80:83], v[100:103], v[156:159]
    v_mfma_f32_16x16x32_bf16 v[160:163], v[36:39], v[96:99], v[160:163]
    v_mfma_f32_16x16x32_bf16 v[164:167], v[40:43], v[96:99], v[164:167]
    v_mfma_f32_16x16x32_bf16 v[168:171], v[44:47], v[96:99], v[168:171]
    v_mfma_f32_16x16x32_bf16 v[172:175], v[48:51], v[96:99], v[172:175]
    v_mfma_f32_16x16x32_bf16 v[176:179], v[36:39], v[100:103], v[176:179]
    v_mfma_f32_16x16x32_bf16 v[180:183], v[40:43], v[100:103], v[180:183]
    v_mfma_f32_16x16x32_bf16 v[184:187], v[44:47], v[100:103], v[184:187]
    v_mfma_f32_16x16x32_bf16 v[188:191], v[48:51], v[100:103], v[188:191]
    v_mfma_f32_16x16x32_bf16 v[160:163], v[52:55], v[100:103], v[160:163]
    ds_write_b128 v4, v[128:131] offset:0
    v_mfma_f32_16x16x32_bf16 v[164:167], v[56:59], v[100:103], v[164:167]
    v_mfma_f32_16x16x32_bf16 v[168:171], v[60:63], v[100:103], v[168:171]
    ds_write_b128 v4, v[132:135] offset:1024
    v_mfma_f32_16x16x32_bf16 v[172:175], v[64:67], v[100:103], v[172:175]
    v_mfma_f32_16x16x32_bf16 v[176:179], v[52:55], v[104:107], v[176:179]
    ds_write_b128 v4, v[136:139] offset:2048
    v_mfma_f32_16x16x32_bf16 v[180:183], v[56:59], v[104:107], v[180:183]
    v_mfma_f32_16x16x32_bf16 v[184:187], v[60:63], v[104:107], v[184:187]
    ds_write_b128 v4, v[140:143] offset:3072
    v_mfma_f32_16x16x32_bf16 v[188:191], v[64:67], v[104:107], v[188:191]
    v_mfma_f32_16x16x32_bf16 v[160:163], v[68:71], v[104:107], v[160:163]
    ds_write_b128 v4, v[144:147] offset:4096
    v_mfma_f32_16x16x32_bf16 v[164:167], v[72:75], v[104:107], v[164:167]
    v_mfma_f32_16x16x32_bf16 v[168:171], v[76:79], v[104:107], v[168:171]
    ds_write_b128 v4, v[148:151] offset:5120
    v_mfma_f32_16x16x32_bf16 v[172:175], v[80:83], v[104:107], v[172:175]
    v_mfma_f32_16x16x32_bf16 v[176:179], v[68:71], v[108:111], v[176:179]
    ds_write_b128 v4, v[152:155] offset:6144
    v_mfma_f32_16x16x32_bf16 v[180:183], v[72:75], v[108:111], v[180:183]
    v_mfma_f32_16x16x32_bf16 v[184:187], v[76:79], v[108:111], v[184:187]
    ds_write_b128 v4, v[156:159] offset:7168
    v_mfma_f32_16x16x32_bf16 v[188:191], v[80:83], v[108:111], v[188:191]
    v_mfma_f32_16x16x32_bf16 v[192:195], v[36:39], v[104:107], v[192:195]
    v_mfma_f32_16x16x32_bf16 v[196:199], v[40:43], v[104:107], v[196:199]
    v_mfma_f32_16x16x32_bf16 v[200:203], v[44:47], v[104:107], v[200:203]
    v_mfma_f32_16x16x32_bf16 v[204:207], v[48:51], v[104:107], v[204:207]
    v_mfma_f32_16x16x32_bf16 v[208:211], v[36:39], v[108:111], v[208:211]
    v_mfma_f32_16x16x32_bf16 v[212:215], v[40:43], v[108:111], v[212:215]
    v_mfma_f32_16x16x32_bf16 v[216:219], v[44:47], v[108:111], v[216:219]
    v_mfma_f32_16x16x32_bf16 v[220:223], v[48:51], v[108:111], v[220:223]
    v_mfma_f32_16x16x32_bf16 v[192:195], v[52:55], v[108:111], v[192:195]
    ds_write_b128 v4, v[160:163] offset:8192
    v_mfma_f32_16x16x32_bf16 v[196:199], v[56:59], v[108:111], v[196:199]
    v_mfma_f32_16x16x32_bf16 v[200:203], v[60:63], v[108:111], v[200:203]
    ds_write_b128 v4, v[164:167] offset:9216
    v_mfma_f32_16x16x32_bf16 v[204:207], v[64:67], v[108:111], v[204:207]
    v_mfma_f32_16x16x32_bf16 v[208:211], v[52:55], v[112:115], v[208:211]
    ds_write_b128 v4, v[168:171] offset:10240
    v_mfma_f32_16x16x32_bf16 v[212:215], v[56:59], v[112:115], v[212:215]
    v_mfma_f32_16x16x32_bf16 v[216:219], v[60:63], v[112:115], v[216:219]
    ds_write_b128 v4, v[172:175] offset:11264
    v_mfma_f32_16x16x32_bf16 v[220:223], v[64:67], v[112:115], v[220:223]
    v_mfma_f32_16x16x32_bf16 v[192:195], v[68:71], v[112:115], v[192:195]
    ds_write_b128 v4, v[176:179] offset:12288
    v_mfma_f32_16x16x32_bf16 v[196:199], v[72:75], v[112:115], v[196:199]
    v_mfma_f32_16x16x32_bf16 v[200:203], v[76:79], v[112:115], v[200:203]
    ds_write_b128 v4, v[180:183] offset:13312
    v_mfma_f32_16x16x32_bf16 v[204:207], v[80:83], v[112:115], v[204:207]
    v_mfma_f32_16x16x32_bf16 v[208:211], v[68:71], v[116:119], v[208:211]
    ds_write_b128 v4, v[184:187] offset:14336
    v_mfma_f32_16x16x32_bf16 v[212:215], v[72:75], v[116:119], v[212:215]
    v_mfma_f32_16x16x32_bf16 v[216:219], v[76:79], v[116:119], v[216:219]
    ds_write_b128 v4, v[188:191] offset:15360
    v_mfma_f32_16x16x32_bf16 v[220:223], v[80:83], v[116:119], v[220:223]
    v_mfma_f32_16x16x32_bf16 v[224:227], v[36:39], v[112:115], v[224:227]
    v_mfma_f32_16x16x32_bf16 v[228:231], v[40:43], v[112:115], v[228:231]
    v_mfma_f32_16x16x32_bf16 v[232:235], v[44:47], v[112:115], v[232:235]
    v_mfma_f32_16x16x32_bf16 v[236:239], v[48:51], v[112:115], v[236:239]
    v_mfma_f32_16x16x32_bf16 v[240:243], v[36:39], v[116:119], v[240:243]
    v_mfma_f32_16x16x32_bf16 v[244:247], v[40:43], v[116:119], v[244:247]
    v_mfma_f32_16x16x32_bf16 v[248:251], v[44:47], v[116:119], v[248:251]
    v_mfma_f32_16x16x32_bf16 v[252:255], v[48:51], v[116:119], v[252:255]
    v_mfma_f32_16x16x32_bf16 v[224:227], v[52:55], v[116:119], v[224:227]
    ds_write_b128 v5, v[192:195] offset:0
    v_mfma_f32_16x16x32_bf16 v[228:231], v[56:59], v[116:119], v[228:231]
    v_mfma_f32_16x16x32_bf16 v[232:235], v[60:63], v[116:119], v[232:235]
    ds_write_b128 v5, v[196:199] offset:1024
    v_mfma_f32_16x16x32_bf16 v[236:239], v[64:67], v[116:119], v[236:239]
    v_mfma_f32_16x16x32_bf16 v[240:243], v[52:55], v[120:123], v[240:243]
    ds_write_b128 v5, v[200:203] offset:2048
    v_mfma_f32_16x16x32_bf16 v[244:247], v[56:59], v[120:123], v[244:247]
    v_mfma_f32_16x16x32_bf16 v[248:251], v[60:63], v[120:123], v[248:251]
    ds_write_b128 v5, v[204:207] offset:3072
    v_mfma_f32_16x16x32_bf16 v[252:255], v[64:67], v[120:123], v[252:255]
    v_mfma_f32_16x16x32_bf16 v[224:227], v[68:71], v[120:123], v[224:227]
    ds_write_b128 v5, v[208:211] offset:4096
    v_mfma_f32_16x16x32_bf16 v[228:231], v[72:75], v[120:123], v[228:231]
    v_mfma_f32_16x16x32_bf16 v[232:235], v[76:79], v[120:123], v[232:235]
    ds_write_b128 v5, v[212:215] offset:5120
    v_mfma_f32_16x16x32_bf16 v[236:239], v[80:83], v[120:123], v[236:239]
    v_mfma_f32_16x16x32_bf16 v[240:243], v[68:71], v[124:127], v[240:243]
    ds_write_b128 v5, v[216:219] offset:6144
    v_mfma_f32_16x16x32_bf16 v[244:247], v[72:75], v[124:127], v[244:247]
    v_mfma_f32_16x16x32_bf16 v[248:251], v[76:79], v[124:127], v[248:251]
    ds_write_b128 v5, v[220:223] offset:7168
    v_mfma_f32_16x16x32_bf16 v[252:255], v[80:83], v[124:127], v[252:255]

    v_mov_b32 v7, 155648
    s_cmp_lt_u32 s28, 2
    s_cselect_b32 s57, 73728, 0
    s_mov_b32 s58, 16384
    s_cselect_b32 s58, 20480, s58
    s_and_b32 s32, s28, 1
    s_lshl_b32 s32, s32, 13
    s_add_u32 s57, s57, s32
    s_lshl_b32 s32, s38, 12
    s_add_u32 s59, s57, s32
    s_xor_b32 s32, s32, 4096
    s_add_u32 s57, s57, s32
    v_add_u32 v8, s59, v34
    v_add_u32 v12, s57, v34
    v_add_u32 v9, s58, v8
    v_add_u32 v13, s58, v12
    v_add_u32 v10, s58, v9
    v_add_u32 v14, s58, v13
    v_add_u32 v11, s58, v10
    v_add_u32 v15, s58, v14
    ds_write_b128 v5, v[224:227] offset:8192
    ds_write_b128 v5, v[228:231] offset:9216
    ds_write_b128 v5, v[232:235] offset:10240
    ds_write_b128 v5, v[236:239] offset:11264
    ds_write_b128 v5, v[240:243] offset:12288
    ds_write_b128 v5, v[244:247] offset:13312
    ds_write_b128 v5, v[248:251] offset:14336
    ds_write_b128 v5, v[252:255] offset:15360
    s_waitcnt lgkmcnt(0)
    s_barrier
    ds_read_b32 v6, v7
    ds_read_b128 v[128:131], v8 offset:0
    ds_read_b128 v[132:135], v8 offset:1024
    ds_read_b128 v[136:139], v8 offset:2048
    ds_read_b128 v[140:143], v8 offset:3072
    ds_read_b128 v[144:147], v9 offset:0
    ds_read_b128 v[148:151], v9 offset:1024
    ds_read_b128 v[152:155], v9 offset:2048
    ds_read_b128 v[156:159], v9 offset:3072
    ds_read_b128 v[160:163], v10 offset:0
    ds_read_b128 v[164:167], v10 offset:1024
    ds_read_b128 v[168:171], v10 offset:2048
    ds_read_b128 v[172:175], v10 offset:3072
    ds_read_b128 v[176:179], v11 offset:0
    ds_read_b128 v[180:183], v11 offset:1024
    ds_read_b128 v[184:187], v11 offset:2048
    ds_read_b128 v[188:191], v11 offset:3072

    s_mov_b32 s50, 0x4038aa3b
    s_mov_b32 s51, 0xbfb8aa3b
    s_cmp_eq_u32 s38, 1
    s_cselect_b32 s50, s50, s51
    s_cselect_b32 s51, 1.0, 0
    s_cselect_b32 s52, -2.0, 1.0
    v_mov_b32 v16, s51
    v_mov_b32 v17, s51
    v_mov_b32 v18, s50
    v_mov_b32 v19, s50
    v_mov_b32 v20, s52
    v_mov_b32 v21, s52
    v_mov_b32 v22, 1.0
    v_mov_b32 v23, 1.0
    s_lshl_b32 s32, s38, 11
    s_add_u32 s33, s54, s32
    s_xor_b32 s32, s32, 2048
    s_add_u32 s54, s54, s32
    s_add_u32 s57, s55, s32
    s_xor_b32 s32, s32, 2048
    s_add_u32 s58, s55, s32
    ds_read_b128 v[192:195], v12 offset:0
    ds_read_b128 v[196:199], v12 offset:1024
    ds_read_b128 v[200:203], v12 offset:2048
    ds_read_b128 v[204:207], v12 offset:3072
    ds_read_b128 v[208:211], v13 offset:0
    ds_read_b128 v[212:215], v13 offset:1024
    ds_read_b128 v[216:219], v13 offset:2048
    ds_read_b128 v[220:223], v13 offset:3072
    ds_read_b128 v[224:227], v14 offset:0
    ds_read_b128 v[228:231], v14 offset:1024
    ds_read_b128 v[232:235], v14 offset:2048
    ds_read_b128 v[236:239], v14 offset:3072
    ds_read_b128 v[240:243], v15 offset:0
    ds_read_b128 v[244:247], v15 offset:1024
    ds_read_b128 v[248:251], v15 offset:2048
    ds_read_b128 v[252:255], v15 offset:3072
    s_waitcnt lgkmcnt(14)
    v_readfirstlane_b32 s59, v6
    v_pk_add_f32 v[128:129], v[128:129], v[144:145]
    v_pk_add_f32 v[130:131], v[130:131], v[146:147]
    v_pk_add_f32 v[132:133], v[132:133], v[148:149]
    v_pk_add_f32 v[134:135], v[134:135], v[150:151]
    v_pk_add_f32 v[136:137], v[136:137], v[152:153]
    v_pk_add_f32 v[138:139], v[138:139], v[154:155]
    v_pk_add_f32 v[140:141], v[140:141], v[156:157]
    v_pk_add_f32 v[142:143], v[142:143], v[158:159]
    v_pk_add_f32 v[160:161], v[160:161], v[176:177]
    v_pk_add_f32 v[162:163], v[162:163], v[178:179]
    v_pk_add_f32 v[164:165], v[164:165], v[180:181]
    v_pk_add_f32 v[166:167], v[166:167], v[182:183]
    v_pk_add_f32 v[168:169], v[168:169], v[184:185]
    v_pk_add_f32 v[170:171], v[170:171], v[186:187]
    v_pk_add_f32 v[172:173], v[172:173], v[188:189]
    v_pk_add_f32 v[174:175], v[174:175], v[190:191]
    v_pk_add_f32 v[128:129], v[128:129], v[160:161]
    v_pk_add_f32 v[130:131], v[130:131], v[162:163]
    v_pk_add_f32 v[132:133], v[132:133], v[164:165]
    v_pk_add_f32 v[134:135], v[134:135], v[166:167]
    v_pk_add_f32 v[136:137], v[136:137], v[168:169]
    v_pk_add_f32 v[138:139], v[138:139], v[170:171]
    v_pk_add_f32 v[140:141], v[140:141], v[172:173]
    v_pk_add_f32 v[142:143], v[142:143], v[174:175]
    v_pk_mul_f32 v[128:129], v[128:129], v[18:19]
    v_pk_mul_f32 v[130:131], v[130:131], v[18:19]
    v_pk_mul_f32 v[132:133], v[132:133], v[18:19]
    v_pk_mul_f32 v[134:135], v[134:135], v[18:19]
    v_pk_mul_f32 v[136:137], v[136:137], v[18:19]
    v_pk_mul_f32 v[138:139], v[138:139], v[18:19]
    v_pk_mul_f32 v[140:141], v[140:141], v[18:19]
    v_pk_mul_f32 v[142:143], v[142:143], v[18:19]
    v_exp_f32 v128, v128
    v_exp_f32 v129, v129
    v_exp_f32 v130, v130
    v_exp_f32 v131, v131
    v_exp_f32 v132, v132
    v_exp_f32 v133, v133
    v_exp_f32 v134, v134
    v_exp_f32 v135, v135
    v_exp_f32 v136, v136
    v_exp_f32 v137, v137
    v_exp_f32 v138, v138
    v_exp_f32 v139, v139
    v_exp_f32 v140, v140
    v_exp_f32 v141, v141
    v_exp_f32 v142, v142
    v_exp_f32 v143, v143
    v_pk_add_f32 v[128:129], v[128:129], v[22:23]
    v_pk_add_f32 v[130:131], v[130:131], v[22:23]
    v_pk_add_f32 v[132:133], v[132:133], v[22:23]
    v_pk_add_f32 v[134:135], v[134:135], v[22:23]
    v_pk_add_f32 v[136:137], v[136:137], v[22:23]
    v_pk_add_f32 v[138:139], v[138:139], v[22:23]
    v_pk_add_f32 v[140:141], v[140:141], v[22:23]
    v_pk_add_f32 v[142:143], v[142:143], v[22:23]
    v_rcp_f32 v128, v128
    v_rcp_f32 v129, v129
    v_rcp_f32 v130, v130
    v_rcp_f32 v131, v131
    v_rcp_f32 v132, v132
    v_rcp_f32 v133, v133
    v_rcp_f32 v134, v134
    v_rcp_f32 v135, v135
    v_rcp_f32 v136, v136
    v_rcp_f32 v137, v137
    v_rcp_f32 v138, v138
    v_rcp_f32 v139, v139
    v_rcp_f32 v140, v140
    v_rcp_f32 v141, v141
    v_rcp_f32 v142, v142
    v_rcp_f32 v143, v143
    v_pk_fma_f32 v[128:129], v[128:129], v[20:21], v[16:17]
    v_pk_fma_f32 v[130:131], v[130:131], v[20:21], v[16:17]
    v_pk_fma_f32 v[132:133], v[132:133], v[20:21], v[16:17]
    v_pk_fma_f32 v[134:135], v[134:135], v[20:21], v[16:17]
    v_pk_fma_f32 v[136:137], v[136:137], v[20:21], v[16:17]
    v_pk_fma_f32 v[138:139], v[138:139], v[20:21], v[16:17]
    v_pk_fma_f32 v[140:141], v[140:141], v[20:21], v[16:17]
    v_pk_fma_f32 v[142:143], v[142:143], v[20:21], v[16:17]
    v_cvt_pk_bf16_f32 v40, v128, v129
    v_cvt_pk_bf16_f32 v41, v130, v131
    v_cvt_pk_bf16_f32 v42, v132, v133
    v_cvt_pk_bf16_f32 v43, v134, v135
    v_cvt_pk_bf16_f32 v44, v136, v137
    v_cvt_pk_bf16_f32 v45, v138, v139
    v_cvt_pk_bf16_f32 v46, v140, v141
    v_cvt_pk_bf16_f32 v47, v142, v143
    buffer_store_dwordx4 v[40:43], v34, s[20:23], s33 offen offset:0 sc0 sc1
    buffer_store_dwordx4 v[44:47], v34, s[20:23], s33 offen offset:1024 sc0 sc1
    s_waitcnt lgkmcnt(0)
    v_pk_add_f32 v[192:193], v[192:193], v[208:209]
    v_pk_add_f32 v[194:195], v[194:195], v[210:211]
    v_pk_add_f32 v[196:197], v[196:197], v[212:213]
    v_pk_add_f32 v[198:199], v[198:199], v[214:215]
    v_pk_add_f32 v[200:201], v[200:201], v[216:217]
    v_pk_add_f32 v[202:203], v[202:203], v[218:219]
    v_pk_add_f32 v[204:205], v[204:205], v[220:221]
    v_pk_add_f32 v[206:207], v[206:207], v[222:223]
    v_pk_add_f32 v[224:225], v[224:225], v[240:241]
    v_pk_add_f32 v[226:227], v[226:227], v[242:243]
    v_pk_add_f32 v[228:229], v[228:229], v[244:245]
    v_pk_add_f32 v[230:231], v[230:231], v[246:247]
    v_pk_add_f32 v[232:233], v[232:233], v[248:249]
    v_pk_add_f32 v[234:235], v[234:235], v[250:251]
    v_pk_add_f32 v[236:237], v[236:237], v[252:253]
    v_pk_add_f32 v[238:239], v[238:239], v[254:255]
    v_pk_add_f32 v[192:193], v[192:193], v[224:225]
    v_pk_add_f32 v[194:195], v[194:195], v[226:227]
    v_pk_add_f32 v[196:197], v[196:197], v[228:229]
    v_pk_add_f32 v[198:199], v[198:199], v[230:231]
    v_pk_add_f32 v[200:201], v[200:201], v[232:233]
    v_pk_add_f32 v[202:203], v[202:203], v[234:235]
    v_pk_add_f32 v[204:205], v[204:205], v[236:237]
    v_pk_add_f32 v[206:207], v[206:207], v[238:239]
    v_pk_mul_f32 v[192:193], v[192:193], v[18:19]
    v_pk_mul_f32 v[194:195], v[194:195], v[18:19]
    v_pk_mul_f32 v[196:197], v[196:197], v[18:19]
    v_pk_mul_f32 v[198:199], v[198:199], v[18:19]
    v_pk_mul_f32 v[200:201], v[200:201], v[18:19]
    v_pk_mul_f32 v[202:203], v[202:203], v[18:19]
    v_pk_mul_f32 v[204:205], v[204:205], v[18:19]
    v_pk_mul_f32 v[206:207], v[206:207], v[18:19]
    v_exp_f32 v192, v192
    v_exp_f32 v193, v193
    v_exp_f32 v194, v194
    v_exp_f32 v195, v195
    v_exp_f32 v196, v196
    v_exp_f32 v197, v197
    v_exp_f32 v198, v198
    v_exp_f32 v199, v199
    v_exp_f32 v200, v200
    v_exp_f32 v201, v201
    v_exp_f32 v202, v202
    v_exp_f32 v203, v203
    v_exp_f32 v204, v204
    v_exp_f32 v205, v205
    v_exp_f32 v206, v206
    v_exp_f32 v207, v207
    v_pk_add_f32 v[192:193], v[192:193], v[22:23]
    v_pk_add_f32 v[194:195], v[194:195], v[22:23]
    v_pk_add_f32 v[196:197], v[196:197], v[22:23]
    v_pk_add_f32 v[198:199], v[198:199], v[22:23]
    v_pk_add_f32 v[200:201], v[200:201], v[22:23]
    v_pk_add_f32 v[202:203], v[202:203], v[22:23]
    v_pk_add_f32 v[204:205], v[204:205], v[22:23]
    v_pk_add_f32 v[206:207], v[206:207], v[22:23]
    v_rcp_f32 v192, v192
    v_rcp_f32 v193, v193
    v_rcp_f32 v194, v194
    v_rcp_f32 v195, v195
    v_rcp_f32 v196, v196
    v_rcp_f32 v197, v197
    v_rcp_f32 v198, v198
    v_rcp_f32 v199, v199
    v_rcp_f32 v200, v200
    v_rcp_f32 v201, v201
    v_rcp_f32 v202, v202
    v_rcp_f32 v203, v203
    v_rcp_f32 v204, v204
    v_rcp_f32 v205, v205
    v_rcp_f32 v206, v206
    v_rcp_f32 v207, v207
    v_pk_fma_f32 v[192:193], v[192:193], v[20:21], v[16:17]
    v_pk_fma_f32 v[194:195], v[194:195], v[20:21], v[16:17]
    v_pk_fma_f32 v[196:197], v[196:197], v[20:21], v[16:17]
    v_pk_fma_f32 v[198:199], v[198:199], v[20:21], v[16:17]
    v_pk_fma_f32 v[200:201], v[200:201], v[20:21], v[16:17]
    v_pk_fma_f32 v[202:203], v[202:203], v[20:21], v[16:17]
    v_pk_fma_f32 v[204:205], v[204:205], v[20:21], v[16:17]
    v_pk_fma_f32 v[206:207], v[206:207], v[20:21], v[16:17]
    v_cvt_pk_bf16_f32 v48, v192, v193
    v_cvt_pk_bf16_f32 v49, v194, v195
    v_cvt_pk_bf16_f32 v50, v196, v197
    v_cvt_pk_bf16_f32 v51, v198, v199
    v_cvt_pk_bf16_f32 v52, v200, v201
    v_cvt_pk_bf16_f32 v53, v202, v203
    v_cvt_pk_bf16_f32 v54, v204, v205
    v_cvt_pk_bf16_f32 v55, v206, v207

    s_cmp_eq_u32 s59, 1
    s_cbranch_scc1 L_nosend2
    buffer_store_dwordx4 v[48:51], v34, s[20:23], s54 offen offset:0 sc0 sc1
    buffer_store_dwordx4 v[52:55], v34, s[20:23], s54 offen offset:1024 sc0 sc1

    s_cmp_eq_u32 s59, 0
    s_cbranch_scc1 L_fin
L_nosend2:
    v_and_b32 v4, 15, v2
    v_lshrrev_b32 v5, 4, v2
    s_lshl_b32 s32, s28, 1
    v_lshl_add_u32 v4, v4, 3, s32
    s_xor_b32 s32, s38, 1
    v_add_u32 v6, s32, v4
    v_add_u32 v7, s38, v4
    v_cmp_gt_u32 vcc, 125, v6
    s_mov_b64 s[96:97], vcc
    v_cmp_gt_u32 vcc, 125, v7
    s_mov_b64 s[98:99], vcc
    v_and_b32 v4, 1, v5
    v_lshlrev_b32 v4, 5, v4
    v_lshrrev_b32 v5, 1, v5
    v_lshl_add_u32 v4, v5, 4, v4
    s_lshl_b32 s32, s39, 7
    v_add_u32 v4, s32, v4
    v_lshl_add_u32 v6, v6, 1, s40
    v_lshl_add_u32 v7, v7, 1, s40
    v_lshl_add_u32 v6, v6, 10, v4
    v_lshl_add_u32 v7, v7, 10, v4
    s_mov_b32 s50, 1073758208
L_poll1:
    buffer_load_dwordx4 v[56:59], v34, s[20:23], s57 offen sc0 sc1
    buffer_load_dwordx4 v[60:63], v34, s[20:23], s57 offen offset:1024 sc0 sc1
L_chk1:
    s_waitcnt vmcnt(0)
    v_cmp_eq_u32 s[4:5], s50, v56
    s_mov_b64 vcc, s[4:5]
    v_cmp_eq_u32 s[6:7], s50, v57
    s_or_b64 vcc, vcc, s[6:7]
    v_cmp_eq_u32 s[4:5], s50, v58
    s_or_b64 vcc, vcc, s[4:5]
    v_cmp_eq_u32 s[6:7], s50, v59
    s_or_b64 vcc, vcc, s[6:7]
    v_cmp_eq_u32 s[4:5], s50, v60
    s_or_b64 vcc, vcc, s[4:5]
    v_cmp_eq_u32 s[6:7], s50, v61
    s_or_b64 vcc, vcc, s[6:7]
    v_cmp_eq_u32 s[4:5], s50, v62
    s_or_b64 vcc, vcc, s[4:5]
    v_cmp_eq_u32 s[6:7], s50, v63
    s_or_b64 vcc, vcc, s[6:7]
    s_cbranch_vccnz L_poll1
    v_lshlrev_b32 v72, 16, v48
    v_and_b32 v73, 0xffff0000, v48
    v_lshlrev_b32 v74, 16, v56
    v_and_b32 v75, 0xffff0000, v56
    v_pk_mul_f32 v[72:73], v[72:73], v[74:75]
    v_cvt_pk_bf16_f32 v56, v72, v73
    v_lshlrev_b32 v72, 16, v49
    v_and_b32 v73, 0xffff0000, v49
    v_lshlrev_b32 v74, 16, v57
    v_and_b32 v75, 0xffff0000, v57
    v_pk_mul_f32 v[72:73], v[72:73], v[74:75]
    v_cvt_pk_bf16_f32 v57, v72, v73
    v_lshlrev_b32 v72, 16, v50
    v_and_b32 v73, 0xffff0000, v50
    v_lshlrev_b32 v74, 16, v58
    v_and_b32 v75, 0xffff0000, v58
    v_pk_mul_f32 v[72:73], v[72:73], v[74:75]
    v_cvt_pk_bf16_f32 v58, v72, v73
    v_lshlrev_b32 v72, 16, v51
    v_and_b32 v73, 0xffff0000, v51
    v_lshlrev_b32 v74, 16, v59
    v_and_b32 v75, 0xffff0000, v59
    v_pk_mul_f32 v[72:73], v[72:73], v[74:75]
    v_cvt_pk_bf16_f32 v59, v72, v73
    v_lshlrev_b32 v72, 16, v52
    v_and_b32 v73, 0xffff0000, v52
    v_lshlrev_b32 v74, 16, v60
    v_and_b32 v75, 0xffff0000, v60
    v_pk_mul_f32 v[72:73], v[72:73], v[74:75]
    v_cvt_pk_bf16_f32 v60, v72, v73
    v_lshlrev_b32 v72, 16, v53
    v_and_b32 v73, 0xffff0000, v53
    v_lshlrev_b32 v74, 16, v61
    v_and_b32 v75, 0xffff0000, v61
    v_pk_mul_f32 v[72:73], v[72:73], v[74:75]
    v_cvt_pk_bf16_f32 v61, v72, v73
    v_lshlrev_b32 v72, 16, v54
    v_and_b32 v73, 0xffff0000, v54
    v_lshlrev_b32 v74, 16, v62
    v_and_b32 v75, 0xffff0000, v62
    v_pk_mul_f32 v[72:73], v[72:73], v[74:75]
    v_cvt_pk_bf16_f32 v62, v72, v73
    v_lshlrev_b32 v72, 16, v55
    v_and_b32 v73, 0xffff0000, v55
    v_lshlrev_b32 v74, 16, v63
    v_and_b32 v75, 0xffff0000, v63
    v_pk_mul_f32 v[72:73], v[72:73], v[74:75]
    v_cvt_pk_bf16_f32 v63, v72, v73
    s_nop 1
    v_permlane16_swap_b32 v56, v58
    v_permlane16_swap_b32 v57, v59
    v_permlane16_swap_b32 v60, v62
    v_permlane16_swap_b32 v61, v63
    s_mov_b64 exec, s[96:97]
    buffer_store_dwordx4 v[56:59], v6, s[16:19], 0 offen offset:0 sc0 sc1
    buffer_store_dwordx4 v[60:63], v6, s[16:19], 0 offen offset:64 sc0 sc1
    s_mov_b64 exec, -1
    s_nop 1
    s_cmp_eq_u32 s59, 2
    s_cbranch_scc0 L_fin
L_poll0:
    buffer_load_dwordx4 v[56:59], v34, s[20:23], s58 offen sc0 sc1
    buffer_load_dwordx4 v[60:63], v34, s[20:23], s58 offen offset:1024 sc0 sc1
L_chk0:
    s_waitcnt vmcnt(0)
    v_cmp_eq_u32 s[4:5], s50, v56
    s_mov_b64 vcc, s[4:5]
    v_cmp_eq_u32 s[6:7], s50, v57
    s_or_b64 vcc, vcc, s[6:7]
    v_cmp_eq_u32 s[4:5], s50, v58
    s_or_b64 vcc, vcc, s[4:5]
    v_cmp_eq_u32 s[6:7], s50, v59
    s_or_b64 vcc, vcc, s[6:7]
    v_cmp_eq_u32 s[4:5], s50, v60
    s_or_b64 vcc, vcc, s[4:5]
    v_cmp_eq_u32 s[6:7], s50, v61
    s_or_b64 vcc, vcc, s[6:7]
    v_cmp_eq_u32 s[4:5], s50, v62
    s_or_b64 vcc, vcc, s[4:5]
    v_cmp_eq_u32 s[6:7], s50, v63
    s_or_b64 vcc, vcc, s[6:7]
    s_cbranch_vccnz L_poll0
    v_lshlrev_b32 v72, 16, v40
    v_and_b32 v73, 0xffff0000, v40
    v_lshlrev_b32 v74, 16, v56
    v_and_b32 v75, 0xffff0000, v56
    v_pk_mul_f32 v[72:73], v[72:73], v[74:75]
    v_cvt_pk_bf16_f32 v56, v72, v73
    v_lshlrev_b32 v72, 16, v41
    v_and_b32 v73, 0xffff0000, v41
    v_lshlrev_b32 v74, 16, v57
    v_and_b32 v75, 0xffff0000, v57
    v_pk_mul_f32 v[72:73], v[72:73], v[74:75]
    v_cvt_pk_bf16_f32 v57, v72, v73
    v_lshlrev_b32 v72, 16, v42
    v_and_b32 v73, 0xffff0000, v42
    v_lshlrev_b32 v74, 16, v58
    v_and_b32 v75, 0xffff0000, v58
    v_pk_mul_f32 v[72:73], v[72:73], v[74:75]
    v_cvt_pk_bf16_f32 v58, v72, v73
    v_lshlrev_b32 v72, 16, v43
    v_and_b32 v73, 0xffff0000, v43
    v_lshlrev_b32 v74, 16, v59
    v_and_b32 v75, 0xffff0000, v59
    v_pk_mul_f32 v[72:73], v[72:73], v[74:75]
    v_cvt_pk_bf16_f32 v59, v72, v73
    v_lshlrev_b32 v72, 16, v44
    v_and_b32 v73, 0xffff0000, v44
    v_lshlrev_b32 v74, 16, v60
    v_and_b32 v75, 0xffff0000, v60
    v_pk_mul_f32 v[72:73], v[72:73], v[74:75]
    v_cvt_pk_bf16_f32 v60, v72, v73
    v_lshlrev_b32 v72, 16, v45
    v_and_b32 v73, 0xffff0000, v45
    v_lshlrev_b32 v74, 16, v61
    v_and_b32 v75, 0xffff0000, v61
    v_pk_mul_f32 v[72:73], v[72:73], v[74:75]
    v_cvt_pk_bf16_f32 v61, v72, v73
    v_lshlrev_b32 v72, 16, v46
    v_and_b32 v73, 0xffff0000, v46
    v_lshlrev_b32 v74, 16, v62
    v_and_b32 v75, 0xffff0000, v62
    v_pk_mul_f32 v[72:73], v[72:73], v[74:75]
    v_cvt_pk_bf16_f32 v62, v72, v73
    v_lshlrev_b32 v72, 16, v47
    v_and_b32 v73, 0xffff0000, v47
    v_lshlrev_b32 v74, 16, v63
    v_and_b32 v75, 0xffff0000, v63
    v_pk_mul_f32 v[72:73], v[72:73], v[74:75]
    v_cvt_pk_bf16_f32 v63, v72, v73
    s_nop 1
    v_permlane16_swap_b32 v56, v58
    v_permlane16_swap_b32 v57, v59
    v_permlane16_swap_b32 v60, v62
    v_permlane16_swap_b32 v61, v63
    s_mov_b64 exec, s[98:99]
    buffer_store_dwordx4 v[56:59], v7, s[16:19], 0 offen offset:0 sc0 sc1
    buffer_store_dwordx4 v[60:63], v7, s[16:19], 0 offen offset:64 sc0 sc1
    s_mov_b64 exec, -1
    s_nop 1
L_fin:
L_done:
    s_endpgm
L_helper:

    v_lshrrev_b32 v3, 3, v2
    s_lshl_b32 s32, s37, 3
    v_add_u32 v3, s32, v3
    v_lshlrev_b32 v3, 11, v3
    v_and_b32 v4, 7, v2
    v_lshl_add_u32 v3, v4, 4, v3
    s_lshl_b32 s32, s39, 7
    s_lshl_b32 s33, s38, 10
    s_xor_b32 s33, s33, 1024
    s_add_u32 s32, s32, s33
    v_add_u32 v3, s32, v3

    s_waitcnt lgkmcnt(0)
    s_mov_b32 s12, s6
    s_and_b32 s13, s7, 0xffff
    s_mov_b32 s14, 15728640
    s_mov_b32 s15, 0x00020000
    s_add_u32 s32, s44, 0
    buffer_load_dwordx4 v[8:11], v3, s[12:15], s32 offen
    s_add_u32 s32, s44, 1048576
    buffer_load_dwordx4 v[8:11], v3, s[12:15], s32 offen
    s_add_u32 s32, s44, 2097152
    buffer_load_dwordx4 v[8:11], v3, s[12:15], s32 offen
    s_add_u32 s32, s44, 3145728
    buffer_load_dwordx4 v[8:11], v3, s[12:15], s32 offen
    s_add_u32 s32, s44, 4194304
    buffer_load_dwordx4 v[8:11], v3, s[12:15], s32 offen
    s_add_u32 s32, s44, 5242880
    buffer_load_dwordx4 v[8:11], v3, s[12:15], s32 offen
    s_add_u32 s32, s44, 6291456
    buffer_load_dwordx4 v[8:11], v3, s[12:15], s32 offen
    s_add_u32 s32, s44, 7340032
    buffer_load_dwordx4 v[8:11], v3, s[12:15], s32 offen
    s_add_u32 s32, s44, 8388608
    buffer_load_dwordx4 v[8:11], v3, s[12:15], s32 offen
    s_add_u32 s32, s44, 9437184
    buffer_load_dwordx4 v[8:11], v3, s[12:15], s32 offen
    s_add_u32 s32, s44, 10485760
    buffer_load_dwordx4 v[8:11], v3, s[12:15], s32 offen
    s_add_u32 s32, s44, 11534336
    buffer_load_dwordx4 v[8:11], v3, s[12:15], s32 offen
    s_add_u32 s32, s44, 12582912
    buffer_load_dwordx4 v[8:11], v3, s[12:15], s32 offen
    s_add_u32 s32, s44, 13631488
    buffer_load_dwordx4 v[8:11], v3, s[12:15], s32 offen
    s_add_u32 s32, s44, 14680064
    buffer_load_dwordx4 v[8:11], v3, s[12:15], s32 offen
    s_barrier

    s_mov_b32 s8, s4
    s_and_b32 s9, s5, 0xffff
    s_mov_b32 s10, 2048000
    s_mov_b32 s11, 0x00020000
    s_mov_b32 s24, s66
    s_and_b32 s25, s67, 0xffff
    s_mov_b32 s26, 256
    s_mov_b32 s27, 0x00020000
    s_mov_b32 s20, s68
    s_and_b32 s21, s69, 0xffff
    s_mov_b32 s22, 0x10000000
    s_mov_b32 s23, 0x00020000
    s_sub_u32 s32, s40, 28
    v_mov_b32 v1, 0x40000000
    v_lshrrev_b32 v12, 4, v2
    v_and_b32 v4, 15, v2
    s_sub_u32 s29, s40, 28
    v_add_u32 v5, 0, v12
    v_and_b32 v6, 7, v5
    v_lshlrev_b32 v6, 1, v6
    v_xor_b32 v6, v6, v4
    v_lshlrev_b32 v6, 4, v6
    v_lshl_add_u32 v5, v5, 3, 0
    v_add_u32 v7, s41, v5
    v_cmp_gt_u32 vcc, 14, v7
    v_lshl_add_u32 v5, v5, 1, s29
    v_lshl_add_u32 v5, v5, 10, v6
    v_cndmask_b32 v64, v5, v1, vcc
    v_add_u32 v5, 4, v12
    v_and_b32 v6, 7, v5
    v_lshlrev_b32 v6, 1, v6
    v_xor_b32 v6, v6, v4
    v_lshlrev_b32 v6, 4, v6
    v_lshl_add_u32 v5, v5, 3, 0
    v_add_u32 v7, s41, v5
    v_cmp_gt_u32 vcc, 14, v7
    v_lshl_add_u32 v5, v5, 1, s29
    v_lshl_add_u32 v5, v5, 10, v6
    v_cndmask_b32 v65, v5, v1, vcc
    v_add_u32 v5, 8, v12
    v_and_b32 v6, 7, v5
    v_lshlrev_b32 v6, 1, v6
    v_xor_b32 v6, v6, v4
    v_lshlrev_b32 v6, 4, v6
    v_lshl_add_u32 v5, v5, 3, 0
    v_add_u32 v7, s41, v5
    v_cmp_gt_u32 vcc, 14, v7
    v_lshl_add_u32 v5, v5, 1, s29
    v_lshl_add_u32 v5, v5, 10, v6
    v_cndmask_b32 v66, v5, v1, vcc
    v_add_u32 v5, 12, v12
    v_and_b32 v6, 7, v5
    v_lshlrev_b32 v6, 1, v6
    v_xor_b32 v6, v6, v4
    v_lshlrev_b32 v6, 4, v6
    v_lshl_add_u32 v5, v5, 3, 0
    v_add_u32 v7, s41, v5
    v_cmp_gt_u32 vcc, 14, v7
    v_lshl_add_u32 v5, v5, 1, s29
    v_lshl_add_u32 v5, v5, 10, v6
    v_cndmask_b32 v67, v5, v1, vcc
    v_add_u32 v5, 16, v12
    v_cmp_le_u32 vcc, 18, v5
    v_subrev_u32 v6, 18, v5
    v_mov_b32 v7, 0
    v_cndmask_b32 v5, v5, v6, vcc
    v_cndmask_b32 v7, v7, 1, vcc
    v_and_b32 v6, 7, v5
    v_lshlrev_b32 v6, 1, v6
    v_xor_b32 v6, v6, v4
    v_lshlrev_b32 v6, 4, v6
    v_lshl_add_u32 v5, v5, 3, v7
    v_add_u32 v7, s41, v5
    v_cmp_gt_u32 vcc, 14, v7
    v_lshl_add_u32 v5, v5, 1, s29
    v_lshl_add_u32 v5, v5, 10, v6
    v_cndmask_b32 v68, v5, v1, vcc
    v_add_u32 v5, 2, v12
    v_and_b32 v6, 7, v5
    v_lshlrev_b32 v6, 1, v6
    v_xor_b32 v6, v6, v4
    v_lshlrev_b32 v6, 4, v6
    v_lshl_add_u32 v5, v5, 3, 1
    v_add_u32 v7, s41, v5
    v_cmp_gt_u32 vcc, 14, v7
    v_lshl_add_u32 v5, v5, 1, s29
    v_lshl_add_u32 v5, v5, 10, v6
    v_cndmask_b32 v69, v5, v1, vcc
    v_add_u32 v5, 6, v12
    v_and_b32 v6, 7, v5
    v_lshlrev_b32 v6, 1, v6
    v_xor_b32 v6, v6, v4
    v_lshlrev_b32 v6, 4, v6
    v_lshl_add_u32 v5, v5, 3, 1
    v_add_u32 v7, s41, v5
    v_cmp_gt_u32 vcc, 14, v7
    v_lshl_add_u32 v5, v5, 1, s29
    v_lshl_add_u32 v5, v5, 10, v6
    v_cndmask_b32 v70, v5, v1, vcc
    v_add_u32 v5, 10, v12
    v_and_b32 v6, 7, v5
    v_lshlrev_b32 v6, 1, v6
    v_xor_b32 v6, v6, v4
    v_lshlrev_b32 v6, 4, v6
    v_lshl_add_u32 v5, v5, 3, 1
    v_add_u32 v7, s41, v5
    v_cmp_gt_u32 vcc, 14, v7
    v_lshl_add_u32 v5, v5, 1, s29
    v_lshl_add_u32 v5, v5, 10, v6
    v_cndmask_b32 v71, v5, v1, vcc
    v_add_u32 v5, 14, v12
    v_and_b32 v6, 7, v5
    v_lshlrev_b32 v6, 1, v6
    v_xor_b32 v6, v6, v4
    v_lshlrev_b32 v6, 4, v6
    v_lshl_add_u32 v5, v5, 3, 1
    v_add_u32 v7, s41, v5
    v_cmp_gt_u32 vcc, 14, v7
    v_lshl_add_u32 v5, v5, 1, s29
    v_lshl_add_u32 v5, v5, 10, v6
    v_cndmask_b32 v72, v5, v1, vcc
    v_add_u32 v5, 0, v12
    v_and_b32 v6, 7, v5
    v_lshlrev_b32 v6, 1, v6
    v_xor_b32 v6, v6, v4
    v_lshlrev_b32 v6, 4, v6
    v_lshl_add_u32 v5, v5, 3, 2
    v_add_u32 v7, s41, v5
    v_cmp_gt_u32 vcc, 14, v7
    v_lshl_add_u32 v5, v5, 1, s29
    v_lshl_add_u32 v5, v5, 10, v6
    v_cndmask_b32 v73, v5, v1, vcc
    v_add_u32 v5, 4, v12
    v_and_b32 v6, 7, v5
    v_lshlrev_b32 v6, 1, v6
    v_xor_b32 v6, v6, v4
    v_lshlrev_b32 v6, 4, v6
    v_lshl_add_u32 v5, v5, 3, 2
    v_add_u32 v7, s41, v5
    v_cmp_gt_u32 vcc, 14, v7
    v_lshl_add_u32 v5, v5, 1, s29
    v_lshl_add_u32 v5, v5, 10, v6
    v_cndmask_b32 v74, v5, v1, vcc
    v_add_u32 v5, 8, v12
    v_and_b32 v6, 7, v5
    v_lshlrev_b32 v6, 1, v6
    v_xor_b32 v6, v6, v4
    v_lshlrev_b32 v6, 4, v6
    v_lshl_add_u32 v5, v5, 3, 2
    v_add_u32 v7, s41, v5
    v_cmp_gt_u32 vcc, 14, v7
    v_lshl_add_u32 v5, v5, 1, s29
    v_lshl_add_u32 v5, v5, 10, v6
    v_cndmask_b32 v75, v5, v1, vcc
    v_add_u32 v5, 12, v12
    v_and_b32 v6, 7, v5
    v_lshlrev_b32 v6, 1, v6
    v_xor_b32 v6, v6, v4
    v_lshlrev_b32 v6, 4, v6
    v_lshl_add_u32 v5, v5, 3, 2
    v_add_u32 v7, s41, v5
    v_cmp_gt_u32 vcc, 14, v7
    v_lshl_add_u32 v5, v5, 1, s29
    v_lshl_add_u32 v5, v5, 10, v6
    v_cndmask_b32 v76, v5, v1, vcc
    v_add_u32 v5, 16, v12
    v_cmp_le_u32 vcc, 18, v5
    v_subrev_u32 v6, 18, v5
    v_mov_b32 v7, 2
    v_cndmask_b32 v5, v5, v6, vcc
    v_cndmask_b32 v7, v7, 3, vcc
    v_and_b32 v6, 7, v5
    v_lshlrev_b32 v6, 1, v6
    v_xor_b32 v6, v6, v4
    v_lshlrev_b32 v6, 4, v6
    v_lshl_add_u32 v5, v5, 3, v7
    v_add_u32 v7, s41, v5
    v_cmp_gt_u32 vcc, 14, v7
    v_lshl_add_u32 v5, v5, 1, s29
    v_lshl_add_u32 v5, v5, 10, v6
    v_cndmask_b32 v77, v5, v1, vcc
    v_add_u32 v5, 2, v12
    v_and_b32 v6, 7, v5
    v_lshlrev_b32 v6, 1, v6
    v_xor_b32 v6, v6, v4
    v_lshlrev_b32 v6, 4, v6
    v_lshl_add_u32 v5, v5, 3, 3
    v_add_u32 v7, s41, v5
    v_cmp_gt_u32 vcc, 14, v7
    v_lshl_add_u32 v5, v5, 1, s29
    v_lshl_add_u32 v5, v5, 10, v6
    v_cndmask_b32 v78, v5, v1, vcc
    v_add_u32 v5, 6, v12
    v_and_b32 v6, 7, v5
    v_lshlrev_b32 v6, 1, v6
    v_xor_b32 v6, v6, v4
    v_lshlrev_b32 v6, 4, v6
    v_lshl_add_u32 v5, v5, 3, 3
    v_add_u32 v7, s41, v5
    v_cmp_gt_u32 vcc, 14, v7
    v_lshl_add_u32 v5, v5, 1, s29
    v_lshl_add_u32 v5, v5, 10, v6
    v_cndmask_b32 v79, v5, v1, vcc
    v_add_u32 v5, 10, v12
    v_and_b32 v6, 7, v5
    v_lshlrev_b32 v6, 1, v6
    v_xor_b32 v6, v6, v4
    v_lshlrev_b32 v6, 4, v6
    v_lshl_add_u32 v5, v5, 3, 3
    v_add_u32 v7, s41, v5
    v_cmp_gt_u32 vcc, 14, v7
    v_lshl_add_u32 v5, v5, 1, s29
    v_lshl_add_u32 v5, v5, 10, v6
    v_cndmask_b32 v80, v5, v1, vcc
    v_add_u32 v5, 14, v12
    v_and_b32 v6, 7, v5
    v_lshlrev_b32 v6, 1, v6
    v_xor_b32 v6, v6, v4
    v_lshlrev_b32 v6, 4, v6
    v_lshl_add_u32 v5, v5, 3, 3
    v_add_u32 v7, s41, v5
    v_cmp_gt_u32 vcc, 14, v7
    v_lshl_add_u32 v5, v5, 1, s29
    v_lshl_add_u32 v5, v5, 10, v6
    v_cndmask_b32 v81, v5, v1, vcc
    v_add_u32 v5, 0, v12
    v_and_b32 v6, 7, v5
    v_lshlrev_b32 v6, 1, v6
    v_xor_b32 v6, v6, v4
    v_lshlrev_b32 v6, 4, v6
    v_lshl_add_u32 v5, v5, 3, 4
    v_add_u32 v7, s41, v5
    v_cmp_gt_u32 vcc, 14, v7
    v_lshl_add_u32 v5, v5, 1, s29
    v_lshl_add_u32 v5, v5, 10, v6
    v_cndmask_b32 v82, v5, v1, vcc
    v_add_u32 v5, 4, v12
    v_and_b32 v6, 7, v5
    v_lshlrev_b32 v6, 1, v6
    v_xor_b32 v6, v6, v4
    v_lshlrev_b32 v6, 4, v6
    v_lshl_add_u32 v5, v5, 3, 4
    v_add_u32 v7, s41, v5
    v_cmp_gt_u32 vcc, 14, v7
    v_lshl_add_u32 v5, v5, 1, s29
    v_lshl_add_u32 v5, v5, 10, v6
    v_cndmask_b32 v83, v5, v1, vcc
    v_add_u32 v5, 8, v12
    v_and_b32 v6, 7, v5
    v_lshlrev_b32 v6, 1, v6
    v_xor_b32 v6, v6, v4
    v_lshlrev_b32 v6, 4, v6
    v_lshl_add_u32 v5, v5, 3, 4
    v_add_u32 v7, s41, v5
    v_cmp_gt_u32 vcc, 14, v7
    v_lshl_add_u32 v5, v5, 1, s29
    v_lshl_add_u32 v5, v5, 10, v6
    v_cndmask_b32 v84, v5, v1, vcc
    v_add_u32 v5, 12, v12
    v_and_b32 v6, 7, v5
    v_lshlrev_b32 v6, 1, v6
    v_xor_b32 v6, v6, v4
    v_lshlrev_b32 v6, 4, v6
    v_lshl_add_u32 v5, v5, 3, 4
    v_add_u32 v7, s41, v5
    v_cmp_gt_u32 vcc, 14, v7
    v_lshl_add_u32 v5, v5, 1, s29
    v_lshl_add_u32 v5, v5, 10, v6
    v_cndmask_b32 v85, v5, v1, vcc
    v_add_u32 v5, 16, v12
    v_cmp_le_u32 vcc, 18, v5
    v_subrev_u32 v6, 18, v5
    v_mov_b32 v7, 4
    v_cndmask_b32 v5, v5, v6, vcc
    v_cndmask_b32 v7, v7, 5, vcc
    v_and_b32 v6, 7, v5
    v_lshlrev_b32 v6, 1, v6
    v_xor_b32 v6, v6, v4
    v_lshlrev_b32 v6, 4, v6
    v_lshl_add_u32 v5, v5, 3, v7
    v_add_u32 v7, s41, v5
    v_cmp_gt_u32 vcc, 14, v7
    v_lshl_add_u32 v5, v5, 1, s29
    v_lshl_add_u32 v5, v5, 10, v6
    v_cndmask_b32 v86, v5, v1, vcc
    v_add_u32 v5, 2, v12
    v_and_b32 v6, 7, v5
    v_lshlrev_b32 v6, 1, v6
    v_xor_b32 v6, v6, v4
    v_lshlrev_b32 v6, 4, v6
    v_lshl_add_u32 v5, v5, 3, 5
    v_add_u32 v7, s41, v5
    v_cmp_gt_u32 vcc, 14, v7
    v_lshl_add_u32 v5, v5, 1, s29
    v_lshl_add_u32 v5, v5, 10, v6
    v_cndmask_b32 v87, v5, v1, vcc
    v_add_u32 v5, 6, v12
    v_and_b32 v6, 7, v5
    v_lshlrev_b32 v6, 1, v6
    v_xor_b32 v6, v6, v4
    v_lshlrev_b32 v6, 4, v6
    v_lshl_add_u32 v5, v5, 3, 5
    v_add_u32 v7, s41, v5
    v_cmp_gt_u32 vcc, 14, v7
    v_lshl_add_u32 v5, v5, 1, s29
    v_lshl_add_u32 v5, v5, 10, v6
    v_cndmask_b32 v88, v5, v1, vcc
    v_add_u32 v5, 10, v12
    v_and_b32 v6, 7, v5
    v_lshlrev_b32 v6, 1, v6
    v_xor_b32 v6, v6, v4
    v_lshlrev_b32 v6, 4, v6
    v_lshl_add_u32 v5, v5, 3, 5
    v_add_u32 v7, s41, v5
    v_cmp_gt_u32 vcc, 14, v7
    v_lshl_add_u32 v5, v5, 1, s29
    v_lshl_add_u32 v5, v5, 10, v6
    v_cndmask_b32 v89, v5, v1, vcc
    v_add_u32 v5, 14, v12
    v_and_b32 v6, 7, v5
    v_lshlrev_b32 v6, 1, v6
    v_xor_b32 v6, v6, v4
    v_lshlrev_b32 v6, 4, v6
    v_lshl_add_u32 v5, v5, 3, 5
    v_add_u32 v7, s41, v5
    v_cmp_gt_u32 vcc, 14, v7
    v_lshl_add_u32 v5, v5, 1, s29
    v_lshl_add_u32 v5, v5, 10, v6
    v_cndmask_b32 v90, v5, v1, vcc
    v_add_u32 v5, 0, v12
    v_and_b32 v6, 7, v5
    v_lshlrev_b32 v6, 1, v6
    v_xor_b32 v6, v6, v4
    v_lshlrev_b32 v6, 4, v6
    v_lshl_add_u32 v5, v5, 3, 6
    v_add_u32 v7, s41, v5
    v_cmp_gt_u32 vcc, 14, v7
    v_lshl_add_u32 v5, v5, 1, s29
    v_lshl_add_u32 v5, v5, 10, v6
    v_cndmask_b32 v91, v5, v1, vcc
    v_add_u32 v5, 4, v12
    v_and_b32 v6, 7, v5
    v_lshlrev_b32 v6, 1, v6
    v_xor_b32 v6, v6, v4
    v_lshlrev_b32 v6, 4, v6
    v_lshl_add_u32 v5, v5, 3, 6
    v_add_u32 v7, s41, v5
    v_cmp_gt_u32 vcc, 14, v7
    v_lshl_add_u32 v5, v5, 1, s29
    v_lshl_add_u32 v5, v5, 10, v6
    v_cndmask_b32 v92, v5, v1, vcc
    v_add_u32 v5, 8, v12
    v_and_b32 v6, 7, v5
    v_lshlrev_b32 v6, 1, v6
    v_xor_b32 v6, v6, v4
    v_lshlrev_b32 v6, 4, v6
    v_lshl_add_u32 v5, v5, 3, 6
    v_add_u32 v7, s41, v5
    v_cmp_gt_u32 vcc, 14, v7
    v_lshl_add_u32 v5, v5, 1, s29
    v_lshl_add_u32 v5, v5, 10, v6
    v_cndmask_b32 v93, v5, v1, vcc
    v_add_u32 v5, 12, v12
    v_and_b32 v6, 7, v5
    v_lshlrev_b32 v6, 1, v6
    v_xor_b32 v6, v6, v4
    v_lshlrev_b32 v6, 4, v6
    v_lshl_add_u32 v5, v5, 3, 6
    v_add_u32 v7, s41, v5
    v_cmp_gt_u32 vcc, 14, v7
    v_lshl_add_u32 v5, v5, 1, s29
    v_lshl_add_u32 v5, v5, 10, v6
    v_cndmask_b32 v94, v5, v1, vcc
    v_add_u32 v5, 16, v12
    v_cmp_le_u32 vcc, 18, v5
    v_subrev_u32 v6, 18, v5
    v_mov_b32 v7, 6
    v_cndmask_b32 v5, v5, v6, vcc
    v_cndmask_b32 v7, v7, 7, vcc
    v_and_b32 v6, 7, v5
    v_lshlrev_b32 v6, 1, v6
    v_xor_b32 v6, v6, v4
    v_lshlrev_b32 v6, 4, v6
    v_lshl_add_u32 v5, v5, 3, v7
    v_add_u32 v7, s41, v5
    v_cmp_gt_u32 vcc, 14, v7
    v_lshl_add_u32 v5, v5, 1, s29
    v_lshl_add_u32 v5, v5, 10, v6
    v_cndmask_b32 v95, v5, v1, vcc
    v_add_u32 v5, 2, v12
    v_and_b32 v6, 7, v5
    v_lshlrev_b32 v6, 1, v6
    v_xor_b32 v6, v6, v4
    v_lshlrev_b32 v6, 4, v6
    v_lshl_add_u32 v5, v5, 3, 7
    v_add_u32 v7, s41, v5
    v_cmp_gt_u32 vcc, 14, v7
    v_lshl_add_u32 v5, v5, 1, s29
    v_lshl_add_u32 v5, v5, 10, v6
    v_cndmask_b32 v96, v5, v1, vcc
    v_add_u32 v5, 6, v12
    v_and_b32 v6, 7, v5
    v_lshlrev_b32 v6, 1, v6
    v_xor_b32 v6, v6, v4
    v_lshlrev_b32 v6, 4, v6
    v_lshl_add_u32 v5, v5, 3, 7
    v_add_u32 v7, s41, v5
    v_cmp_gt_u32 vcc, 14, v7
    v_lshl_add_u32 v5, v5, 1, s29
    v_lshl_add_u32 v5, v5, 10, v6
    v_cndmask_b32 v97, v5, v1, vcc
    v_add_u32 v5, 10, v12
    v_and_b32 v6, 7, v5
    v_lshlrev_b32 v6, 1, v6
    v_xor_b32 v6, v6, v4
    v_lshlrev_b32 v6, 4, v6
    v_lshl_add_u32 v5, v5, 3, 7
    v_add_u32 v7, s41, v5
    v_cmp_gt_u32 vcc, 14, v7
    v_lshl_add_u32 v5, v5, 1, s29
    v_lshl_add_u32 v5, v5, 10, v6
    v_cndmask_b32 v98, v5, v1, vcc
    v_add_u32 v5, 14, v12
    v_and_b32 v6, 7, v5
    v_lshlrev_b32 v6, 1, v6
    v_xor_b32 v6, v6, v4
    v_lshlrev_b32 v6, 4, v6
    v_lshl_add_u32 v5, v5, 3, 7
    v_add_u32 v7, s41, v5
    v_cmp_gt_u32 vcc, 14, v7
    v_lshl_add_u32 v5, v5, 1, s29
    v_lshl_add_u32 v5, v5, 10, v6
    v_cndmask_b32 v99, v5, v1, vcc

    s_lshl_b32 s32, s39, 4
    s_add_u32 s32, s32, s37
    s_lshr_b32 s33, s32, 3
    s_lshl_b32 s33, s33, 2
    s_add_u32 s33, s33, 64
    v_mov_b32 v31, s33
    s_and_b32 s56, s32, 7
    s_lshl_b32 s56, s56, 2
    s_xor_b32 s33, s38, 1
    s_add_u32 s33, s33, s56
    s_lshl_b32 s43, 1, s33
    s_lshl_b32 s53, 4, s33
    s_lshl_b32 s32, s32, 15
    s_lshl_b32 s33, s38, 14
    s_add_u32 s54, s32, s33
    v_lshlrev_b32 v34, 4, v2
    v_mov_b32 v16, 1073758208
    v_mov_b32 v17, 1073758208
    v_mov_b32 v18, 1073758208
    v_mov_b32 v19, 1073758208
    v_mov_b32 v32, s43
    v_mov_b32 v33, s53
    s_add_u32 s32, s45, 0
    s_waitcnt vmcnt(15)
    buffer_load_dwordx4 v[8:11], v3, s[12:15], s32 offen
    s_add_u32 s32, s45, 1048576
    s_waitcnt vmcnt(15)
    buffer_load_dwordx4 v[8:11], v3, s[12:15], s32 offen
    s_add_u32 s32, s45, 2097152
    s_waitcnt vmcnt(15)
    buffer_load_dwordx4 v[8:11], v3, s[12:15], s32 offen
    s_add_u32 s32, s45, 3145728
    s_waitcnt vmcnt(15)
    buffer_load_dwordx4 v[8:11], v3, s[12:15], s32 offen
    s_add_u32 s32, s45, 4194304
    s_waitcnt vmcnt(15)
    buffer_load_dwordx4 v[8:11], v3, s[12:15], s32 offen
    s_add_u32 s32, s45, 5242880
    s_waitcnt vmcnt(15)
    buffer_load_dwordx4 v[8:11], v3, s[12:15], s32 offen
    s_add_u32 s32, s45, 6291456
    s_waitcnt vmcnt(15)
    buffer_load_dwordx4 v[8:11], v3, s[12:15], s32 offen
    s_add_u32 s32, s45, 7340032
    s_waitcnt vmcnt(15)
    buffer_load_dwordx4 v[8:11], v3, s[12:15], s32 offen
    s_add_u32 s32, s45, 8388608
    s_waitcnt vmcnt(15)
    buffer_load_dwordx4 v[8:11], v3, s[12:15], s32 offen
    s_add_u32 s32, s45, 9437184
    s_waitcnt vmcnt(15)
    buffer_load_dwordx4 v[8:11], v3, s[12:15], s32 offen
    s_add_u32 s32, s45, 10485760
    s_waitcnt vmcnt(15)
    buffer_load_dwordx4 v[8:11], v3, s[12:15], s32 offen
    s_add_u32 s32, s45, 11534336
    s_waitcnt vmcnt(15)
    buffer_load_dwordx4 v[8:11], v3, s[12:15], s32 offen
    s_add_u32 s32, s45, 12582912
    s_waitcnt vmcnt(15)
    buffer_load_dwordx4 v[8:11], v3, s[12:15], s32 offen
    s_add_u32 s32, s45, 13631488
    s_waitcnt vmcnt(15)
    buffer_load_dwordx4 v[8:11], v3, s[12:15], s32 offen
    s_add_u32 s32, s45, 14680064
    s_waitcnt vmcnt(15)
    buffer_load_dwordx4 v[8:11], v3, s[12:15], s32 offen
    s_mov_b32 m0, 36864
    s_waitcnt vmcnt(15)
    buffer_load_dwordx4 v64, s[8:11], s49 offen  lds
    s_mov_b32 m0, 37888
    s_waitcnt vmcnt(15)
    buffer_load_dwordx4 v65, s[8:11], s49 offen  lds
    s_mov_b32 m0, 38912
    s_waitcnt vmcnt(15)
    buffer_load_dwordx4 v66, s[8:11], s49 offen  lds
    s_mov_b32 m0, 39936
    s_waitcnt vmcnt(15)
    buffer_load_dwordx4 v67, s[8:11], s49 offen  lds
    s_mov_b32 m0, 40960
    s_waitcnt vmcnt(15)
    buffer_load_dwordx4 v68, s[8:11], s49 offen  lds
    s_mov_b32 m0, 41984
    s_waitcnt vmcnt(15)
    buffer_load_dwordx4 v69, s[8:11], s49 offen  lds
    s_mov_b32 m0, 43008
    s_waitcnt vmcnt(15)
    buffer_load_dwordx4 v70, s[8:11], s49 offen  lds
    s_mov_b32 m0, 44032
    s_waitcnt vmcnt(15)
    buffer_load_dwordx4 v71, s[8:11], s49 offen  lds
    s_mov_b32 m0, 45056
    s_waitcnt vmcnt(15)
    buffer_load_dwordx4 v72, s[8:11], s49 offen  lds
    s_mov_b32 m0, 46080
    s_waitcnt vmcnt(15)
    buffer_load_dwordx4 v73, s[8:11], s49 offen  lds
    s_mov_b32 m0, 47104
    s_waitcnt vmcnt(15)
    buffer_load_dwordx4 v74, s[8:11], s49 offen  lds
    s_mov_b32 m0, 48128
    s_waitcnt vmcnt(15)
    buffer_load_dwordx4 v75, s[8:11], s49 offen  lds
    s_mov_b32 m0, 49152
    s_waitcnt vmcnt(15)
    buffer_load_dwordx4 v76, s[8:11], s49 offen  lds
    s_mov_b32 m0, 50176
    s_waitcnt vmcnt(15)
    buffer_load_dwordx4 v77, s[8:11], s49 offen  lds
    s_mov_b32 m0, 51200
    s_waitcnt vmcnt(15)
    buffer_load_dwordx4 v78, s[8:11], s49 offen  lds
    s_mov_b32 m0, 52224
    s_waitcnt vmcnt(15)
    buffer_load_dwordx4 v79, s[8:11], s49 offen  lds
    s_mov_b32 m0, 53248
    s_waitcnt vmcnt(15)
    buffer_load_dwordx4 v80, s[8:11], s49 offen  lds
    s_mov_b32 m0, 54272
    s_waitcnt vmcnt(15)
    buffer_load_dwordx4 v81, s[8:11], s49 offen  lds
    s_mov_b32 m0, 55296
    s_waitcnt vmcnt(15)
    buffer_load_dwordx4 v82, s[8:11], s49 offen  lds
    s_mov_b32 m0, 56320
    s_waitcnt vmcnt(15)
    buffer_load_dwordx4 v83, s[8:11], s49 offen  lds
    s_mov_b32 m0, 57344
    s_waitcnt vmcnt(15)
    buffer_load_dwordx4 v84, s[8:11], s49 offen  lds
    s_mov_b32 m0, 58368
    s_waitcnt vmcnt(15)
    buffer_load_dwordx4 v85, s[8:11], s49 offen  lds
    s_mov_b32 m0, 59392
    s_waitcnt vmcnt(15)
    buffer_load_dwordx4 v86, s[8:11], s49 offen  lds
    s_mov_b32 m0, 60416
    s_waitcnt vmcnt(15)
    buffer_load_dwordx4 v87, s[8:11], s49 offen  lds
    s_mov_b32 m0, 61440
    s_waitcnt vmcnt(15)
    buffer_load_dwordx4 v88, s[8:11], s49 offen  lds
    s_mov_b32 m0, 62464
    s_waitcnt vmcnt(15)
    buffer_load_dwordx4 v89, s[8:11], s49 offen  lds
    s_mov_b32 m0, 63488
    s_waitcnt vmcnt(15)
    buffer_load_dwordx4 v90, s[8:11], s49 offen  lds
    s_mov_b32 m0, 64512
    s_waitcnt vmcnt(15)
    buffer_load_dwordx4 v91, s[8:11], s49 offen  lds
    s_mov_b32 m0, 65536
    s_waitcnt vmcnt(15)
    buffer_load_dwordx4 v92, s[8:11], s49 offen  lds
    s_mov_b32 m0, 66560
    s_waitcnt vmcnt(15)
    buffer_load_dwordx4 v93, s[8:11], s49 offen  lds
    s_mov_b32 m0, 67584
    s_waitcnt vmcnt(15)
    buffer_load_dwordx4 v94, s[8:11], s49 offen  lds
    s_mov_b32 m0, 68608
    s_waitcnt vmcnt(15)
    buffer_load_dwordx4 v95, s[8:11], s49 offen  lds
    s_mov_b32 m0, 69632
    s_waitcnt vmcnt(15)
    buffer_load_dwordx4 v96, s[8:11], s49 offen  lds
    s_mov_b32 m0, 70656
    s_waitcnt vmcnt(15)
    buffer_load_dwordx4 v97, s[8:11], s49 offen  lds
    s_mov_b32 m0, 71680
    s_waitcnt vmcnt(15)
    buffer_load_dwordx4 v98, s[8:11], s49 offen  lds
    s_mov_b32 m0, 72704
    s_waitcnt vmcnt(15)
    buffer_load_dwordx4 v99, s[8:11], s49 offen  lds
    s_add_u32 s32, s46, 0
    buffer_load_dwordx4 v[8:11], v3, s[12:15], s32 offen
    s_add_u32 s32, s46, 1048576
    buffer_load_dwordx4 v[8:11], v3, s[12:15], s32 offen
    s_add_u32 s32, s46, 2097152
    buffer_load_dwordx4 v[8:11], v3, s[12:15], s32 offen
    s_add_u32 s32, s46, 3145728
    buffer_load_dwordx4 v[8:11], v3, s[12:15], s32 offen
    s_add_u32 s32, s46, 4194304
    buffer_load_dwordx4 v[8:11], v3, s[12:15], s32 offen
    s_add_u32 s32, s46, 5242880
    buffer_load_dwordx4 v[8:11], v3, s[12:15], s32 offen
    s_add_u32 s32, s46, 6291456
    buffer_load_dwordx4 v[8:11], v3, s[12:15], s32 offen
    s_add_u32 s32, s46, 7340032
    buffer_load_dwordx4 v[8:11], v3, s[12:15], s32 offen
    s_add_u32 s32, s46, 8388608
    buffer_load_dwordx4 v[8:11], v3, s[12:15], s32 offen
    s_add_u32 s32, s46, 9437184
    buffer_load_dwordx4 v[8:11], v3, s[12:15], s32 offen
    s_add_u32 s32, s46, 10485760
    buffer_load_dwordx4 v[8:11], v3, s[12:15], s32 offen
    s_add_u32 s32, s46, 11534336
    buffer_load_dwordx4 v[8:11], v3, s[12:15], s32 offen
    s_add_u32 s32, s46, 12582912
    buffer_load_dwordx4 v[8:11], v3, s[12:15], s32 offen
    s_add_u32 s32, s46, 13631488
    buffer_load_dwordx4 v[8:11], v3, s[12:15], s32 offen
    s_add_u32 s32, s46, 14680064
    buffer_load_dwordx4 v[8:11], v3, s[12:15], s32 offen
    s_waitcnt vmcnt(15)
    s_barrier
    s_mov_b32 m0, 0
    s_waitcnt vmcnt(15)
    buffer_load_dwordx4 v64, s[8:11], s50 offen  lds
    s_mov_b32 m0, 1024
    s_waitcnt vmcnt(15)
    buffer_load_dwordx4 v65, s[8:11], s50 offen  lds
    s_mov_b32 m0, 2048
    s_waitcnt vmcnt(15)
    buffer_load_dwordx4 v66, s[8:11], s50 offen  lds
    s_mov_b32 m0, 3072
    s_waitcnt vmcnt(15)
    buffer_load_dwordx4 v67, s[8:11], s50 offen  lds
    s_mov_b32 m0, 4096
    s_waitcnt vmcnt(15)
    buffer_load_dwordx4 v68, s[8:11], s50 offen  lds
    s_mov_b32 m0, 5120
    s_waitcnt vmcnt(15)
    buffer_load_dwordx4 v69, s[8:11], s50 offen  lds
    s_mov_b32 m0, 6144
    s_waitcnt vmcnt(15)
    buffer_load_dwordx4 v70, s[8:11], s50 offen  lds
    s_mov_b32 m0, 7168
    s_waitcnt vmcnt(15)
    buffer_load_dwordx4 v71, s[8:11], s50 offen  lds
    s_mov_b32 m0, 8192
    s_waitcnt vmcnt(15)
    buffer_load_dwordx4 v72, s[8:11], s50 offen  lds
    s_mov_b32 m0, 9216
    s_waitcnt vmcnt(15)
    buffer_load_dwordx4 v73, s[8:11], s50 offen  lds
    s_mov_b32 m0, 10240
    s_waitcnt vmcnt(15)
    buffer_load_dwordx4 v74, s[8:11], s50 offen  lds
    s_mov_b32 m0, 11264
    s_waitcnt vmcnt(15)
    buffer_load_dwordx4 v75, s[8:11], s50 offen  lds
    s_mov_b32 m0, 12288
    s_waitcnt vmcnt(15)
    buffer_load_dwordx4 v76, s[8:11], s50 offen  lds
    s_mov_b32 m0, 13312
    s_waitcnt vmcnt(15)
    buffer_load_dwordx4 v77, s[8:11], s50 offen  lds
    s_mov_b32 m0, 14336
    s_waitcnt vmcnt(15)
    buffer_load_dwordx4 v78, s[8:11], s50 offen  lds
    s_mov_b32 m0, 15360
    s_waitcnt vmcnt(15)
    buffer_load_dwordx4 v79, s[8:11], s50 offen  lds
    s_mov_b32 m0, 16384
    s_waitcnt vmcnt(15)
    buffer_load_dwordx4 v80, s[8:11], s50 offen  lds
    s_mov_b32 m0, 17408
    s_waitcnt vmcnt(15)
    buffer_load_dwordx4 v81, s[8:11], s50 offen  lds
    s_mov_b32 m0, 18432
    s_waitcnt vmcnt(15)
    buffer_load_dwordx4 v82, s[8:11], s50 offen  lds
    s_mov_b32 m0, 19456
    s_waitcnt vmcnt(15)
    buffer_load_dwordx4 v83, s[8:11], s50 offen  lds
    s_mov_b32 m0, 20480
    s_waitcnt vmcnt(15)
    buffer_load_dwordx4 v84, s[8:11], s50 offen  lds
    s_mov_b32 m0, 21504
    s_waitcnt vmcnt(15)
    buffer_load_dwordx4 v85, s[8:11], s50 offen  lds
    s_mov_b32 m0, 22528
    s_waitcnt vmcnt(15)
    buffer_load_dwordx4 v86, s[8:11], s50 offen  lds
    s_mov_b32 m0, 23552
    s_waitcnt vmcnt(15)
    buffer_load_dwordx4 v87, s[8:11], s50 offen  lds
    s_mov_b32 m0, 24576
    s_waitcnt vmcnt(15)
    buffer_load_dwordx4 v88, s[8:11], s50 offen  lds
    s_mov_b32 m0, 25600
    s_waitcnt vmcnt(15)
    buffer_load_dwordx4 v89, s[8:11], s50 offen  lds
    s_mov_b32 m0, 26624
    s_waitcnt vmcnt(15)
    buffer_load_dwordx4 v90, s[8:11], s50 offen  lds
    s_mov_b32 m0, 27648
    s_waitcnt vmcnt(15)
    buffer_load_dwordx4 v91, s[8:11], s50 offen  lds
    s_mov_b32 m0, 28672
    s_waitcnt vmcnt(15)
    buffer_load_dwordx4 v92, s[8:11], s50 offen  lds
    s_mov_b32 m0, 29696
    s_waitcnt vmcnt(15)
    buffer_load_dwordx4 v93, s[8:11], s50 offen  lds
    s_mov_b32 m0, 30720
    s_waitcnt vmcnt(15)
    buffer_load_dwordx4 v94, s[8:11], s50 offen  lds
    s_mov_b32 m0, 31744
    s_waitcnt vmcnt(15)
    buffer_load_dwordx4 v95, s[8:11], s50 offen  lds
    s_mov_b32 m0, 32768
    s_waitcnt vmcnt(15)
    buffer_load_dwordx4 v96, s[8:11], s50 offen  lds
    s_mov_b32 m0, 33792
    s_waitcnt vmcnt(15)
    buffer_load_dwordx4 v97, s[8:11], s50 offen  lds
    s_mov_b32 m0, 34816
    s_waitcnt vmcnt(15)
    buffer_load_dwordx4 v98, s[8:11], s50 offen  lds
    s_mov_b32 m0, 35840
    s_waitcnt vmcnt(15)
    buffer_load_dwordx4 v99, s[8:11], s50 offen  lds
    s_add_u32 s32, s47, 0
    buffer_load_dwordx4 v[8:11], v3, s[12:15], s32 offen
    s_add_u32 s32, s47, 1048576
    buffer_load_dwordx4 v[8:11], v3, s[12:15], s32 offen
    s_add_u32 s32, s47, 2097152
    buffer_load_dwordx4 v[8:11], v3, s[12:15], s32 offen
    s_add_u32 s32, s47, 3145728
    buffer_load_dwordx4 v[8:11], v3, s[12:15], s32 offen
    s_add_u32 s32, s47, 4194304
    buffer_load_dwordx4 v[8:11], v3, s[12:15], s32 offen
    s_add_u32 s32, s47, 5242880
    buffer_load_dwordx4 v[8:11], v3, s[12:15], s32 offen
    s_add_u32 s32, s47, 6291456
    buffer_load_dwordx4 v[8:11], v3, s[12:15], s32 offen
    s_add_u32 s32, s47, 7340032
    buffer_load_dwordx4 v[8:11], v3, s[12:15], s32 offen
    s_add_u32 s32, s47, 8388608
    buffer_load_dwordx4 v[8:11], v3, s[12:15], s32 offen
    s_add_u32 s32, s47, 9437184
    buffer_load_dwordx4 v[8:11], v3, s[12:15], s32 offen
    s_add_u32 s32, s47, 10485760
    buffer_load_dwordx4 v[8:11], v3, s[12:15], s32 offen
    s_add_u32 s32, s47, 11534336
    buffer_load_dwordx4 v[8:11], v3, s[12:15], s32 offen
    s_add_u32 s32, s47, 12582912
    buffer_load_dwordx4 v[8:11], v3, s[12:15], s32 offen
    s_add_u32 s32, s47, 13631488
    buffer_load_dwordx4 v[8:11], v3, s[12:15], s32 offen
    s_add_u32 s32, s47, 14680064
    buffer_load_dwordx4 v[8:11], v3, s[12:15], s32 offen
    s_waitcnt vmcnt(15)
    s_barrier
    s_mov_b32 m0, 36864
    s_waitcnt vmcnt(15)
    buffer_load_dwordx4 v64, s[8:11], s51 offen  lds
    s_mov_b32 m0, 37888
    s_waitcnt vmcnt(15)
    buffer_load_dwordx4 v65, s[8:11], s51 offen  lds
    s_mov_b32 m0, 38912
    s_waitcnt vmcnt(15)
    buffer_load_dwordx4 v66, s[8:11], s51 offen  lds
    s_mov_b32 m0, 39936
    s_waitcnt vmcnt(15)
    buffer_load_dwordx4 v67, s[8:11], s51 offen  lds
    s_mov_b32 m0, 40960
    s_waitcnt vmcnt(15)
    buffer_load_dwordx4 v68, s[8:11], s51 offen  lds
    s_mov_b32 m0, 41984
    s_waitcnt vmcnt(15)
    buffer_load_dwordx4 v69, s[8:11], s51 offen  lds
    s_mov_b32 m0, 43008
    s_waitcnt vmcnt(15)
    buffer_load_dwordx4 v70, s[8:11], s51 offen  lds
    s_mov_b32 m0, 44032
    s_waitcnt vmcnt(15)
    buffer_load_dwordx4 v71, s[8:11], s51 offen  lds
    s_mov_b32 m0, 45056
    s_waitcnt vmcnt(15)
    buffer_load_dwordx4 v72, s[8:11], s51 offen  lds
    s_mov_b32 m0, 46080
    s_waitcnt vmcnt(15)
    buffer_load_dwordx4 v73, s[8:11], s51 offen  lds
    s_mov_b32 m0, 47104
    s_waitcnt vmcnt(15)
    buffer_load_dwordx4 v74, s[8:11], s51 offen  lds
    s_mov_b32 m0, 48128
    s_waitcnt vmcnt(15)
    buffer_load_dwordx4 v75, s[8:11], s51 offen  lds
    s_mov_b32 m0, 49152
    s_waitcnt vmcnt(15)
    buffer_load_dwordx4 v76, s[8:11], s51 offen  lds
    s_mov_b32 m0, 50176
    s_waitcnt vmcnt(15)
    buffer_load_dwordx4 v77, s[8:11], s51 offen  lds
    s_mov_b32 m0, 51200
    s_waitcnt vmcnt(15)
    buffer_load_dwordx4 v78, s[8:11], s51 offen  lds
    s_mov_b32 m0, 52224
    s_waitcnt vmcnt(15)
    buffer_load_dwordx4 v79, s[8:11], s51 offen  lds
    s_mov_b32 m0, 53248
    s_waitcnt vmcnt(15)
    buffer_load_dwordx4 v80, s[8:11], s51 offen  lds
    s_mov_b32 m0, 54272
    s_waitcnt vmcnt(15)
    buffer_load_dwordx4 v81, s[8:11], s51 offen  lds
    s_mov_b32 m0, 55296
    s_waitcnt vmcnt(15)
    buffer_load_dwordx4 v82, s[8:11], s51 offen  lds
    s_mov_b32 m0, 56320
    s_waitcnt vmcnt(15)
    buffer_load_dwordx4 v83, s[8:11], s51 offen  lds
    s_mov_b32 m0, 57344
    s_waitcnt vmcnt(15)
    buffer_load_dwordx4 v84, s[8:11], s51 offen  lds
    s_mov_b32 m0, 58368
    s_waitcnt vmcnt(15)
    buffer_load_dwordx4 v85, s[8:11], s51 offen  lds
    s_mov_b32 m0, 59392
    s_waitcnt vmcnt(15)
    buffer_load_dwordx4 v86, s[8:11], s51 offen  lds
    s_mov_b32 m0, 60416
    s_waitcnt vmcnt(15)
    buffer_load_dwordx4 v87, s[8:11], s51 offen  lds
    s_mov_b32 m0, 61440
    s_waitcnt vmcnt(15)
    buffer_load_dwordx4 v88, s[8:11], s51 offen  lds
    s_mov_b32 m0, 62464
    s_waitcnt vmcnt(15)
    buffer_load_dwordx4 v89, s[8:11], s51 offen  lds
    s_mov_b32 m0, 63488
    s_waitcnt vmcnt(15)
    buffer_load_dwordx4 v90, s[8:11], s51 offen  lds
    s_mov_b32 m0, 64512
    s_waitcnt vmcnt(15)
    buffer_load_dwordx4 v91, s[8:11], s51 offen  lds
    s_mov_b32 m0, 65536
    s_waitcnt vmcnt(15)
    buffer_load_dwordx4 v92, s[8:11], s51 offen  lds
    s_mov_b32 m0, 66560
    s_waitcnt vmcnt(15)
    buffer_load_dwordx4 v93, s[8:11], s51 offen  lds
    s_mov_b32 m0, 67584
    s_waitcnt vmcnt(15)
    buffer_load_dwordx4 v94, s[8:11], s51 offen  lds
    s_mov_b32 m0, 68608
    s_waitcnt vmcnt(15)
    buffer_load_dwordx4 v95, s[8:11], s51 offen  lds
    s_mov_b32 m0, 69632
    s_waitcnt vmcnt(15)
    buffer_load_dwordx4 v96, s[8:11], s51 offen  lds
    s_mov_b32 m0, 70656
    s_waitcnt vmcnt(15)
    buffer_load_dwordx4 v97, s[8:11], s51 offen  lds
    s_mov_b32 m0, 71680
    s_waitcnt vmcnt(15)
    buffer_load_dwordx4 v98, s[8:11], s51 offen  lds
    s_mov_b32 m0, 72704
    s_waitcnt vmcnt(15)
    buffer_load_dwordx4 v99, s[8:11], s51 offen  lds
    buffer_store_dwordx4 v[16:19], v34, s[20:23], s54 offen offset:0 sc0 sc1
    buffer_store_dwordx4 v[16:19], v34, s[20:23], s54 offen offset:1024 sc0 sc1
    buffer_store_dwordx4 v[16:19], v34, s[20:23], s54 offen offset:2048 sc0 sc1
    buffer_store_dwordx4 v[16:19], v34, s[20:23], s54 offen offset:3072 sc0 sc1
    s_add_u32 s54, s54, 4096
    buffer_store_dwordx4 v[16:19], v34, s[20:23], s54 offen offset:0 sc0 sc1
    buffer_store_dwordx4 v[16:19], v34, s[20:23], s54 offen offset:1024 sc0 sc1
    buffer_store_dwordx4 v[16:19], v34, s[20:23], s54 offen offset:2048 sc0 sc1
    buffer_store_dwordx4 v[16:19], v34, s[20:23], s54 offen offset:3072 sc0 sc1
    s_add_u32 s54, s54, 4096
    buffer_store_dwordx4 v[16:19], v34, s[20:23], s54 offen offset:0 sc0 sc1
    buffer_store_dwordx4 v[16:19], v34, s[20:23], s54 offen offset:1024 sc0 sc1
    buffer_store_dwordx4 v[16:19], v34, s[20:23], s54 offen offset:2048 sc0 sc1
    buffer_store_dwordx4 v[16:19], v34, s[20:23], s54 offen offset:3072 sc0 sc1
    s_add_u32 s54, s54, 4096
    buffer_store_dwordx4 v[16:19], v34, s[20:23], s54 offen offset:0 sc0 sc1
    buffer_store_dwordx4 v[16:19], v34, s[20:23], s54 offen offset:1024 sc0 sc1
    buffer_store_dwordx4 v[16:19], v34, s[20:23], s54 offen offset:2048 sc0 sc1
    buffer_store_dwordx4 v[16:19], v34, s[20:23], s54 offen offset:3072 sc0 sc1
    s_add_u32 s54, s54, 4096
    s_waitcnt vmcnt(0)
    s_mov_b64 exec, 1
    buffer_atomic_or v32, v31, s[24:27], 0 offen sc0 sc1
    s_mov_b64 exec, -1
    s_barrier
    s_mov_b64 exec, 1
    buffer_atomic_or v33, v31, s[24:27], 0 offen sc0 sc1
    s_mov_b64 exec, -1
    v_mov_b32 v7, 155648
    s_waitcnt vmcnt(0)
    v_readfirstlane_b32 s57, v32
    v_readfirstlane_b32 s58, v33
    s_add_u32 s33, s38, s56
    s_lshr_b32 s57, s57, s33
    s_lshr_b32 s58, s58, s33
    s_and_b32 s58, s58, 1
    s_and_b32 s57, s57, 4
    s_cmp_lg_u32 s57, 0
    s_cselect_b32 s58, 2, s58
    v_mov_b32 v8, s58
    ds_write_b32 v7, v8
    s_waitcnt lgkmcnt(0)
    s_barrier
    s_endpgm

.section .rodata,"a"
.p2align 6
.amdhsa_kernel standalone__autoregressive_conv_wavernn__speech_kernel
  .amdhsa_next_free_vgpr 256
  .amdhsa_next_free_sgpr 100
  .amdhsa_accum_offset 256
  .amdhsa_group_segment_fixed_size 0
  .amdhsa_kernarg_size 40
  .amdhsa_user_sgpr_count 2
  .amdhsa_user_sgpr_kernarg_segment_ptr 1
  .amdhsa_system_sgpr_workgroup_id_x 1
.end_amdhsa_kernel
```
